```python
import torch

def _softmax(x, axis=-1):
    return torch.softmax(x, dim=axis)
def _gelu(x):
    return torch.nn.functional.gelu(x, approximate="tanh")
def _silu(x):
    return torch.nn.functional.silu(x)
def _sigmoid(x):
    return torch.sigmoid(x)
def _layernorm(x, axis=-1, eps=1e-5):
    m = x.mean(dim=axis, keepdim=True)
    v = x.var(dim=axis, keepdim=True, unbiased=False)
    return (x - m) / torch.sqrt(v + eps)
def _scatter_add(tgt, idx, src, axis=0):
    return tgt.clone().index_add_(axis, idx, src)
def _segment_sum(src, seg, n):
    out = torch.zeros((n,) + src.shape[1:], dtype=src.dtype)
    return out.index_add_(0, seg, src)
def _pad(x, pw):
    flat = tuple(v for pair in reversed(pw) for v in pair)
    return torch.nn.functional.pad(x, flat)

kernel_name = 'gated_mix__ssm_conv_s5__swiglu_ffn__prompt'

def setup_inputs():

    _w = (lambda a: (lambda t: t.to(torch.bfloat16) if t.is_floating_point() else t)(torch.as_tensor(a)))
    def _A_setup():
        B, S, D = 1, 2048, 512
        P = D
        Lambda_re = -0.5 * (lambda _x: torch.exp(torch.as_tensor(_x)))((lambda *s: torch.randn(*s, dtype=torch.bfloat16) * 0.2)(P))
        Lambda_im = (lambda *s: torch.randn(*s, dtype=torch.bfloat16) * 0.4)(P) * 1.0
        B_re = (lambda *s: torch.randn(*s, dtype=torch.bfloat16) * 0.2)(P, D) * (D ** -0.5)
        B_im = (lambda *s: torch.randn(*s, dtype=torch.bfloat16) * 0.2)(P, D) * (D ** -0.5)
        C_re = (lambda *s: torch.randn(*s, dtype=torch.bfloat16) * 0.2)(D, P) * (P ** -0.5)
        C_im = (lambda *s: torch.randn(*s, dtype=torch.bfloat16) * 0.2)(D, P) * (P ** -0.5)
        log_dt = (lambda *s: torch.randn(*s, dtype=torch.bfloat16) * 0.2)(P) * 0.3 - 2.0
        Dskip = (lambda *s: torch.randn(*s, dtype=torch.bfloat16) * 0.05)(D)
        return {
            "x": _w((lambda *s: torch.randn(*s, dtype=torch.bfloat16) * 0.05)(B, S, D)),
            "Lambda_re": _w(Lambda_re),
            "Lambda_im": _w(Lambda_im),
            "B_re": _w(B_re),
            "B_im": _w(B_im),
            "C_re": _w(C_re),
            "C_im": _w(C_im),
            "log_dt": _w(log_dt),
            "Dskip": _w(Dskip),
        }
    _A_in = _A_setup()

    def _B_setup():
        B, S, D, F = 1, 2048, 512, 1376
        return {
            "x": _w((lambda *s: torch.randn(*s, dtype=torch.bfloat16) * 0.05)(B, S, D)),
            "w_gate": _w((lambda *s: torch.randn(*s, dtype=torch.bfloat16) * 0.05)(D, F)),
            "w_up": _w((lambda *s: torch.randn(*s, dtype=torch.bfloat16) * 0.05)(D, F)),
            "w_down": _w((lambda *s: torch.randn(*s, dtype=torch.bfloat16) * 0.05)(F, D)),
        }
    _B_in = _B_setup()

    return {
        "A_x": _A_in["x"],
        "A_Lambda_re": _A_in["Lambda_re"],
        "A_Lambda_im": _A_in["Lambda_im"],
        "A_B_re": _A_in["B_re"],
        "A_B_im": _A_in["B_im"],
        "A_C_re": _A_in["C_re"],
        "A_C_im": _A_in["C_im"],
        "A_log_dt": _A_in["log_dt"],
        "A_Dskip": _A_in["Dskip"],
        "B_x": _B_in["x"],
        "B_w_gate": _B_in["w_gate"],
        "B_w_up": _B_in["w_up"],
        "B_w_down": _B_in["w_down"],
        "gate_w": _w((lambda *s: torch.randn(*s, dtype=torch.bfloat16) * 0.05)(512) * 16.0),
    }

def reference(A_x, A_Lambda_re, A_Lambda_im, A_B_re, A_B_im, A_C_re, A_C_im, A_log_dt, A_Dskip, B_x, B_w_gate, B_w_up, B_w_down, gate_w):
    def _A_ref(x, Lambda_re, Lambda_im, B_re, B_im, C_re, C_im, log_dt, Dskip):
        Bsz, L, H = x.shape
        Lam = Lambda_re + 1j * Lambda_im
        Bmat = B_re + 1j * B_im
        Cmat = C_re + 1j * C_im
        dt = torch.exp(log_dt)
        Lam_bar = torch.exp(dt * Lam)
        B_bar = ((Lam_bar - 1.0) / Lam)[:, None] * Bmat
        Bu = torch.einsum("bld,pd->blp", x + 0j, B_bar)
        h = torch.zeros_like(Bu[:, 0, :])
        hs = []
        for t in range(L):
            h = Lam_bar[None, :] * h + Bu[:, t, :]
            hs.append(h)
        hseq = torch.stack(hs, 1)
        y = 2.0 * torch.einsum("blp,dp->bld", hseq, Cmat).real + x * Dskip[None, None, :]
        return y

    def _B_ref(x, w_gate, w_up, w_down):
        g = _silu(x @ w_gate)
        u = x @ w_up
        return (g * u) @ w_down

    x = A_x
    g = _sigmoid((x * gate_w).sum(-1, keepdims=True))
    a = _A_ref(x, A_Lambda_re, A_Lambda_im, A_B_re, A_B_im, A_C_re, A_C_im, A_log_dt, A_Dskip)
    b = _B_ref(x, B_w_gate, B_w_up, B_w_down)
    return g * a + (1 - g) * b
```

```asm
; @launch grid=(256,1,1) block=(512,1,1) lds=163840
.amdgcn_target "amdgcn-amd-amdhsa--gfx950"
.text
.globl gated_mix__ssm_conv_s5__swiglu_ffn__prompt_kernel
.p2align 8
.type gated_mix__ssm_conv_s5__swiglu_ffn__prompt_kernel,@function
gated_mix__ssm_conv_s5__swiglu_ffn__prompt_kernel:
    s_load_dwordx16 s[4:19], s[0:1], 0
    s_load_dwordx16 s[20:35], s[0:1], 64
    s_load_dwordx2 s[36:37], s[0:1], 128
    s_cmp_ge_u32 s2, 256
    s_cbranch_scc1 L_end
    s_lshr_b32 s82, s2, 3
    s_getpc_b64 s[84:85]
L_pc:
    s_and_b32 s83, s82, 3
    s_mul_i32 s83, s83, 7680
    v_min_u32 v1, 59, v0
    v_lshl_add_u32 v1, v1, 7, s83
    v_min_u32 v1, L_codeend-L_pc-4, v1
    global_load_dword v255, v1, s[84:85]
    v_lshrrev_b32 v1, 6, v0
    v_and_b32 v0, 63, v0
    v_readfirstlane_b32 s3, v1
    s_and_b32 s38, s2, 1
    s_and_b32 s83, s82, 7
    s_lshl3_add_u32 s38, s38, s83
    s_and_b32 s39, s2, 6
    s_lshr_b32 s83, s82, 3
    s_lshl1_add_u32 s39, s39, s83
    s_and_b32 s42, s3, 3
    s_cmp_ge_u32 s3, 4
    s_cbranch_scc1 L_p2
    v_lshrrev_b32 v52, 3, v0
    v_lshrrev_b32 v55, 4, v0
    v_and_b32 v53, 7, v0
    v_xor_b32 v53, v53, v55
    v_lshlrev_b32 v53, 4, v53
    v_xor_b32 v54, 64, v53
    s_lshl2_add_u32 s81, s38, s42
    s_lshl_b32 s81, s81, 15
    v_lshrrev_b32 v57, 5, v0
    v_and_b32 v56, 3, v52
    v_lshl_add_u32 v55, v57, 4, v56
    v_lshl_add_u32 v55, v55, 10, s81
    v_add_u32 v32, v55, v53
    v_add_u32 v33, v55, v54
    v_add_u32 v34, 6144, v32
    v_add_u32 v35, 9216, v33
    v_add_u32 v33, 3072, v33
    s_lshl_b32 s82, s42, 12
    s_mov_b32 m0, s82
    s_and_b32 s72, s2, 6
    s_add_u32 s72, s72, s38
    s_and_b32 s72, s72, 7
    s_lshl_b32 s72, s72, 7
    s_mov_b32 s50, 2097152
    s_mov_b32 s51, 0x20000
    s_waitcnt lgkmcnt(0)
    s_mov_b32 s48, s4
    s_mov_b32 s49, s5
    buffer_load_dwordx4 v32, s[48:51], s72 offen offset:0  lds
    buffer_load_dwordx4 v33, s[48:51], s72 offen offset:1024  lds
    buffer_load_dwordx4 v34, s[48:51], s72 offen offset:2048  lds
    buffer_load_dwordx4 v35, s[48:51], s72 offen offset:3072  lds
    s_and_b32 s3, s42, 1
    s_lshl1_add_u32 s81, s39, s3
    s_lshl_b32 s81, s81, 14
    v_lshl_add_u32 v55, v57, 3, v56
    v_lshl_add_u32 v55, v55, 10, s81
    v_add_u32 v36, v55, v53
    v_add_u32 v37, v55, v54
    v_add_u32 v37, 3072, v37
    s_lshl_b32 s83, s42, 11
    s_add_u32 m0, s83, 16384
    s_cmp_ge_u32 s42, 2
    s_cselect_b32 s52, s12, s10
    s_cselect_b32 s53, s13, s11
    s_mov_b32 s54, 524288
    s_mov_b32 s55, 0x20000
    buffer_load_dwordx4 v36, s[52:55], s72 offen offset:0  lds
    buffer_load_dwordx4 v37, s[52:55], s72 offen offset:1024  lds
    s_and_b32 s3, s39, 3
    s_mov_b32 s87, 1984246288
    s_cmp_eq_u32 s3, 1
    s_cselect_b32 s87, 1969500448, s87
    s_cmp_eq_u32 s3, 2
    s_cselect_b32 s87, 1733567248, s87
    s_cmp_eq_u32 s3, 3
    s_cselect_b32 s87, 1985167888, s87
    s_and_b32 s3, s2, 6
    s_add_u32 s3, s3, s38
    s_and_b32 s3, s3, 7
    s_mul_i32 s3, s3, 0x11111111
    s_add_u32 s87, s87, s3
    s_add_u32 m0, s82, 24576
    s_bfe_u32 s72, s87, 196612
    s_lshl_b32 s72, s72, 7
    buffer_load_dwordx4 v32, s[48:51], s72 offen offset:0  lds
    buffer_load_dwordx4 v33, s[48:51], s72 offen offset:1024  lds
    buffer_load_dwordx4 v34, s[48:51], s72 offen offset:2048  lds
    buffer_load_dwordx4 v35, s[48:51], s72 offen offset:3072  lds
    s_add_u32 m0, s83, 40960
    s_nop 0
    buffer_load_dwordx4 v36, s[52:55], s72 offen offset:0  lds
    buffer_load_dwordx4 v37, s[52:55], s72 offen offset:1024  lds
    s_lshl_b32 s3, s39, 6
    s_cmp_eq_u32 s42, 3
    s_cselect_b32 s3, 0, s3
    s_cselect_b32 s81, 63, 3
    s_cselect_b32 s64, s30, s18
    s_cselect_b32 s65, s31, s19
    v_and_b32 v57, s81, v0
    v_lshl_add_u32 v57, v57, 4, s3
    s_mov_b32 s66, 1024
    s_mov_b32 s67, 0x20000
    s_cmp_eq_u32 s42, 0
    s_cselect_b32 s64, s6, s64
    s_cselect_b32 s65, s7, s65
    s_cmp_eq_u32 s42, 1
    s_cselect_b32 s64, s8, s64
    s_cselect_b32 s65, s9, s65
    s_cmp_eq_u32 s42, 3
    s_cselect_b32 s3, 4, s42
    s_cselect_b64 exec, -1, 15
    s_lshl_b32 s3, s3, 8
    s_add_u32 m0, s3, 158720
    s_nop 0
    buffer_load_dwordx4 v57, s[64:67], 0 offen lds
    s_mov_b64 exec, -1
    s_cmp_lg_u32 s42, 0
    s_cbranch_scc1 L_no_ds
    s_mov_b32 s64, s20
    s_mov_b32 s65, s21
    s_mov_b32 m0, 160768
    v_lshlrev_b32 v57, 4, v0
    buffer_load_dwordx4 v57, s[64:67], 0 offen lds
L_no_ds:
    s_add_u32 s0, s36, 22020096
    s_addc_u32 s1, s37, 0
    s_load_dword s43, s[0:1], 0
    s_mov_b32 s56, s24
    s_mov_b32 s57, s25
    s_mov_b32 s58, 1409024
    s_mov_b32 s59, 0x20000
    s_mov_b32 s60, s26
    s_mov_b32 s61, s27
    s_mov_b32 s62, 1409024
    s_mov_b32 s63, 0x20000
    s_mov_b32 s44, s36
    s_mov_b32 s45, s37
    s_mov_b32 s46, 41943040
    s_mov_b32 s47, 0x20000
    s_mov_b32 s68, s32
    s_mov_b32 s69, s33
    s_mov_b32 s70, 4194304
    s_mov_b32 s71, 0x20000
    s_mov_b32 s64, s28
    s_mov_b32 s65, s29
    s_mov_b32 s66, 1409024
    s_mov_b32 s67, 0x20000
    s_add_u32 s28, s84, L_tab-L_pc
    s_addc_u32 s29, s85, 0
    s_mov_b32 s30, 64
    s_mov_b32 s31, 0x20000
    s_lshl2_add_u32 s26, s42, 157696
    s_mov_b32 s74, 4096
    s_mov_b32 s75, 8192
    s_mov_b32 s76, 12288
    s_mov_b32 s77, 16384
    s_mov_b32 s78, 20480
    s_mov_b32 s79, 24576
    s_mov_b32 s80, 28672
    s_mov_b32 s24, 32768
    s_mov_b32 s25, 36864
    s_lshr_b32 s3, s39, 2
    s_mul_i32 s27, s39, 3
    s_sub_u32 s27, s27, s3
    s_mul_i32 s3, s42, 44032
    s_lshl_b32 s81, s27, 6
    s_add_u32 s3, s3, s81
    s_and_b32 s81, s39, 3
    s_cmp_eq_u32 s81, 3
    s_cselect_b32 s81, 8, 12
    s_cmp_eq_u32 s39, 15
    s_cselect_b32 s81, 4, s81
    v_mov_b32 v55, 1073741824
    v_add_u32 v52, 0, v0
    v_mul_u32_u24 v53, 171, v52
    v_lshrrev_b32 v53, 11, v53
    v_mul_u32_u24 v54, 12, v53
    v_sub_u32 v52, v52, v54
    v_cmp_gt_i32 vcc, s81, v52
    v_lshrrev_b32 v54, 2, v53
    v_and_b32 v54, 2, v54
    v_xor_b32 v52, v52, v54
    v_mul_u32_u24 v53, 2752, v53
    v_lshl_add_u32 v53, v52, 4, v53
    v_add_u32 v53, s3, v53
    v_cndmask_b32 v120, v55, v53, vcc
    v_add_u32 v52, 64, v0
    v_mul_u32_u24 v53, 171, v52
    v_lshrrev_b32 v53, 11, v53
    v_mul_u32_u24 v54, 12, v53
    v_sub_u32 v52, v52, v54
    v_cmp_gt_i32 vcc, s81, v52
    v_lshrrev_b32 v54, 2, v53
    v_and_b32 v54, 2, v54
    v_xor_b32 v52, v52, v54
    v_mul_u32_u24 v53, 2752, v53
    v_lshl_add_u32 v53, v52, 4, v53
    v_subrev_u32 v53, 1024, v53
    v_add_u32 v53, s3, v53
    v_cndmask_b32 v121, v55, v53, vcc
    v_add_u32 v52, 128, v0
    v_mul_u32_u24 v53, 171, v52
    v_lshrrev_b32 v53, 11, v53
    v_mul_u32_u24 v54, 12, v53
    v_sub_u32 v52, v52, v54
    v_cmp_gt_i32 vcc, s81, v52
    v_lshrrev_b32 v54, 2, v53
    v_and_b32 v54, 2, v54
    v_xor_b32 v52, v52, v54
    v_mul_u32_u24 v53, 2752, v53
    v_lshl_add_u32 v53, v52, 4, v53
    v_subrev_u32 v53, 2048, v53
    v_add_u32 v53, s3, v53
    v_cndmask_b32 v122, v55, v53, vcc
    v_bfe_u32 v52, v0, 1, 3
    v_lshrrev_b32 v44, 4, v0
    v_xor_b32 v52, v52, v44
    v_lshlrev_b32 v52, 4, v52
    v_and_b32 v44, 15, v0
    v_lshl_add_u32 v44, v44, 7, v52
    v_xor_b32 v45, 64, v44
    v_add_u32 v44, s82, v44
    v_add_u32 v123, 49152, v44
    v_add_u32 v45, s82, v45
    v_add_u32 v124, 49152, v45
    s_lshl2_add_u32 s3, s42, 157696
    v_mov_b32 v4, s3
    v_and_b32 v5, 3, v0
    v_lshlrev_b32 v5, 2, v5
    v_add_u32 v5, 157696, v5
    v_lshrrev_b32 v125, 4, v0
    v_lshlrev_b32 v125, 4, v125
    v_add_u32 v125, 159744, v125
    s_lshl_b32 s22, s42, 7
    s_add_u32 s22, s22, 157952
    v_and_b32 v127, 31, v0
    v_lshl_add_u32 v127, v127, 2, s22
    v_lshrrev_b32 v52, 4, v0
    v_bfe_u32 v53, v0, 2, 2
    v_lshl_add_u32 v52, v52, 3, v53
    v_mul_u32_u24 v52, 192, v52
    v_bfe_u32 v53, v0, 4, 1
    v_lshl_add_u32 v52, v53, 5, v52
    v_and_b32 v53, 3, v0
    v_lshl_add_u32 v0, v53, 3, v52
    v_xor_b32 v1, 32, v0
    v_add_u32 v2, 98304, v0
    v_add_u32 v3, 98304, v1
    s_mul_i32 s86, s42, 3072
    s_lshr_b32 s40, s39, 2
    s_and_b32 s41, s39, 3
    s_mul_i32 s12, s41, 3
    s_lshl2_add_u32 s10, s38, s42
    s_lshl4_add_u32 s11, s10, s39
    s_lshr_b32 s23, s2, 3
    s_and_b32 s3, s2, 1
    s_mul_i32 s3, s3, 2
    s_add_u32 s23, s23, s3
    s_and_b32 s23, s23, 3
    s_mul_i32 s81, s10, 160
    s_lshl1_add_u32 s81, s27, s81
    s_add_u32 s81, s81, 64
    s_lshl_b32 s34, s81, 11
    s_lshl_b32 s35, s11, 8
    s_add_u32 s35, s35, 21757952
    s_and_b32 s3, s11, -4
    s_lshl_b32 s3, s3, 8
    s_add_u32 s3, s3, 21757952
    s_add_u32 s4, s36, s3
    s_addc_u32 s5, s37, 0
    s_lshl_b32 s3, s11, 10
    s_add_u32 s3, s3, 23068672
    s_add_u32 s6, s36, s3
    s_addc_u32 s7, s37, 0
    s_add_u32 m0, s82, 49152
    s_bfe_u32 s72, s87, 196616
    s_lshl_b32 s72, s72, 7
    buffer_load_dwordx4 v32, s[48:51], s72 offen offset:0  lds
    buffer_load_dwordx4 v33, s[48:51], s72 offen offset:1024  lds
    buffer_load_dwordx4 v34, s[48:51], s72 offen offset:2048  lds
    buffer_load_dwordx4 v35, s[48:51], s72 offen offset:3072  lds
    s_add_u32 m0, s83, 65536
    s_nop 0
    buffer_load_dwordx4 v36, s[52:55], s72 offen offset:0  lds
    buffer_load_dwordx4 v37, s[52:55], s72 offen offset:1024  lds
    s_waitcnt lgkmcnt(0)
    s_add_u32 s43, s43, 0x9E3779B1
    s_waitcnt vmcnt(13)
    s_barrier
    s_add_u32 m0, s82, 73728
    s_bfe_u32 s72, s87, 196620
    s_lshl_b32 s72, s72, 7
    buffer_load_dwordx4 v32, s[48:51], s72 offen offset:0  lds
    ds_read_b128 v[128:131], v44 offset:0
    ds_read_b128 v[132:135], v44 offset:2048
    ds_read_b128 v[136:139], v45 offset:0
    ds_read_b128 v[140:143], v45 offset:2048
    buffer_load_dwordx4 v33, s[48:51], s72 offen offset:1024  lds
    buffer_load_dwordx4 v34, s[48:51], s72 offen offset:2048  lds
    buffer_load_dwordx4 v35, s[48:51], s72 offen offset:3072  lds
    s_add_u32 m0, s83, 90112
    s_nop 0
    buffer_load_dwordx4 v36, s[52:55], s72 offen offset:0  lds
    buffer_load_dwordx4 v37, s[52:55], s72 offen offset:1024  lds
    s_cmp_lg_u32 s23, 0
    s_cbranch_scc1 L_now0_0
    s_add_u32 m0, s86, 98304
    s_bfe_u32 s73, s87, 196608
    s_mul_i32 s73, s73, 176128
    buffer_load_dwordx4 v120, s[56:59], s73 offen offset:0  lds
    buffer_load_dwordx4 v121, s[56:59], s73 offen offset:1024  lds
    buffer_load_dwordx4 v122, s[56:59], s73 offen offset:2048  lds
    s_add_u32 m0, s86, 110592
    s_nop 0
    buffer_load_dwordx4 v120, s[60:63], s73 offen offset:0  lds
    buffer_load_dwordx4 v121, s[60:63], s73 offen offset:1024  lds
    buffer_load_dwordx4 v122, s[60:63], s73 offen offset:2048  lds
L_now0_0:
    s_waitcnt vmcnt(12)
    s_waitcnt lgkmcnt(0)
    s_barrier
    s_add_u32 m0, s82, 0
    s_bfe_u32 s72, s87, 196624
    s_lshl_b32 s72, s72, 7
    buffer_load_dwordx4 v32, s[48:51], s72 offen offset:0  lds
    ds_read_b128 v[144:147], v44 offset:24576
    ds_read_b128 v[148:151], v44 offset:26624
    ds_read_b128 v[152:155], v45 offset:24576
    ds_read_b128 v[156:159], v45 offset:26624
    buffer_load_dwordx4 v33, s[48:51], s72 offen offset:1024  lds
    s_bfe_u32 s3, s87, 196608
    s_lshl_b32 s3, s3, 7
    v_add_u32 v126, s3, v125
    ds_read_b128 v[104:107], v126 offset:0
    ds_read_b128 v[108:111], v126 offset:64
    buffer_load_dwordx4 v34, s[48:51], s72 offen offset:2048  lds
    s_bfe_u32 s3, s87, 196612
    s_lshl_b32 s3, s3, 7
    v_add_u32 v126, s3, v125
    ds_read_b128 v[112:115], v126 offset:0
    ds_read_b128 v[116:119], v126 offset:64
    buffer_load_dwordx4 v35, s[48:51], s72 offen offset:3072  lds
    s_add_u32 m0, s83, 16384
    s_nop 0
    buffer_load_dwordx4 v36, s[52:55], s72 offen offset:0  lds
    buffer_load_dwordx4 v37, s[52:55], s72 offen offset:1024  lds
    s_cmp_lg_u32 s23, 1
    s_cbranch_scc1 L_now0_1
    s_add_u32 m0, s86, 98304
    s_bfe_u32 s73, s87, 196608
    s_mul_i32 s73, s73, 176128
    buffer_load_dwordx4 v120, s[56:59], s73 offen offset:0  lds
    buffer_load_dwordx4 v121, s[56:59], s73 offen offset:1024  lds
    buffer_load_dwordx4 v122, s[56:59], s73 offen offset:2048  lds
    s_add_u32 m0, s86, 110592
    s_nop 0
    buffer_load_dwordx4 v120, s[60:63], s73 offen offset:0  lds
    buffer_load_dwordx4 v121, s[60:63], s73 offen offset:1024  lds
    buffer_load_dwordx4 v122, s[60:63], s73 offen offset:2048  lds
L_now0_1:
    s_waitcnt vmcnt(12)
    s_waitcnt lgkmcnt(0)
    s_barrier
    s_add_u32 m0, s82, 24576
    s_bfe_u32 s72, s87, 196628
    s_lshl_b32 s72, s72, 7
    buffer_load_dwordx4 v32, s[48:51], s72 offen offset:0  lds
    ds_read_b128 v[160:163], v123 offset:0
    ds_read_b128 v[164:167], v123 offset:2048
    ds_read_b128 v[168:171], v124 offset:0
    ds_read_b128 v[172:175], v124 offset:2048
    buffer_load_dwordx4 v33, s[48:51], s72 offen offset:1024  lds
    v_mfma_f32_16x16x32_bf16 v[96:99], v[104:107], v[128:131], 0
    v_mfma_f32_16x16x32_bf16 v[100:103], v[104:107], v[132:135], 0
    v_mfma_f32_16x16x32_bf16 v[96:99], v[108:111], v[136:139], v[96:99]
    v_mfma_f32_16x16x32_bf16 v[100:103], v[108:111], v[140:143], v[100:103]
    buffer_load_dwordx4 v34, s[48:51], s72 offen offset:2048  lds
    v_mfma_f32_16x16x32_bf16 v[96:99], v[112:115], v[144:147], v[96:99]
    v_mfma_f32_16x16x32_bf16 v[100:103], v[112:115], v[148:151], v[100:103]
    v_mfma_f32_16x16x32_bf16 v[96:99], v[116:119], v[152:155], v[96:99]
    v_mfma_f32_16x16x32_bf16 v[100:103], v[116:119], v[156:159], v[100:103]
    buffer_load_dwordx4 v35, s[48:51], s72 offen offset:3072  lds
    s_bfe_u32 s3, s87, 196616
    s_lshl_b32 s3, s3, 7
    v_add_u32 v126, s3, v125
    ds_read_b128 v[104:107], v126 offset:0
    ds_read_b128 v[108:111], v126 offset:64
    s_add_u32 m0, s83, 40960
    s_nop 0
    buffer_load_dwordx4 v36, s[52:55], s72 offen offset:0  lds
    buffer_load_dwordx4 v37, s[52:55], s72 offen offset:1024  lds
    s_cmp_lg_u32 s23, 2
    s_cbranch_scc1 L_now0_2
    s_add_u32 m0, s86, 98304
    s_bfe_u32 s73, s87, 196608
    s_mul_i32 s73, s73, 176128
    buffer_load_dwordx4 v120, s[56:59], s73 offen offset:0  lds
    buffer_load_dwordx4 v121, s[56:59], s73 offen offset:1024  lds
    buffer_load_dwordx4 v122, s[56:59], s73 offen offset:2048  lds
    s_add_u32 m0, s86, 110592
    s_nop 0
    buffer_load_dwordx4 v120, s[60:63], s73 offen offset:0  lds
    buffer_load_dwordx4 v121, s[60:63], s73 offen offset:1024  lds
    buffer_load_dwordx4 v122, s[60:63], s73 offen offset:2048  lds
L_now0_2:
    s_waitcnt vmcnt(12)
    s_waitcnt lgkmcnt(0)
    s_barrier
    s_add_u32 m0, s82, 49152
    s_bfe_u32 s72, s87, 196632
    s_lshl_b32 s72, s72, 7
    buffer_load_dwordx4 v32, s[48:51], s72 offen offset:0  lds
    ds_read_b128 v[176:179], v123 offset:24576
    ds_read_b128 v[180:183], v123 offset:26624
    ds_read_b128 v[184:187], v124 offset:24576
    ds_read_b128 v[188:191], v124 offset:26624
    buffer_load_dwordx4 v33, s[48:51], s72 offen offset:1024  lds
    v_mfma_f32_16x16x32_bf16 v[96:99], v[104:107], v[160:163], v[96:99]
    v_mfma_f32_16x16x32_bf16 v[100:103], v[104:107], v[164:167], v[100:103]
    v_mfma_f32_16x16x32_bf16 v[96:99], v[108:111], v[168:171], v[96:99]
    v_mfma_f32_16x16x32_bf16 v[100:103], v[108:111], v[172:175], v[100:103]
    buffer_load_dwordx4 v34, s[48:51], s72 offen offset:2048  lds
    s_bfe_u32 s3, s87, 196620
    s_lshl_b32 s3, s3, 7
    v_add_u32 v126, s3, v125
    ds_read_b128 v[112:115], v126 offset:0
    ds_read_b128 v[116:119], v126 offset:64
    buffer_load_dwordx4 v35, s[48:51], s72 offen offset:3072  lds
    s_add_u32 m0, s83, 65536
    s_nop 0
    buffer_load_dwordx4 v36, s[52:55], s72 offen offset:0  lds
    buffer_load_dwordx4 v37, s[52:55], s72 offen offset:1024  lds
    s_cmp_lg_u32 s23, 3
    s_cbranch_scc1 L_now0_3
    s_add_u32 m0, s86, 98304
    s_bfe_u32 s73, s87, 196608
    s_mul_i32 s73, s73, 176128
    buffer_load_dwordx4 v120, s[56:59], s73 offen offset:0  lds
    buffer_load_dwordx4 v121, s[56:59], s73 offen offset:1024  lds
    buffer_load_dwordx4 v122, s[56:59], s73 offen offset:2048  lds
    s_add_u32 m0, s86, 110592
    s_nop 0
    buffer_load_dwordx4 v120, s[60:63], s73 offen offset:0  lds
    buffer_load_dwordx4 v121, s[60:63], s73 offen offset:1024  lds
    buffer_load_dwordx4 v122, s[60:63], s73 offen offset:2048  lds
L_now0_3:
    s_waitcnt vmcnt(12)
    s_waitcnt lgkmcnt(0)
    s_barrier
    s_add_u32 m0, s82, 73728
    s_bfe_u32 s72, s87, 196636
    s_lshl_b32 s72, s72, 7
    buffer_load_dwordx4 v32, s[48:51], s72 offen offset:0  lds
    ds_read_b128 v[192:195], v44 offset:0
    ds_read_b128 v[196:199], v44 offset:2048
    ds_read_b128 v[200:203], v45 offset:0
    ds_read_b128 v[204:207], v45 offset:2048
    buffer_load_dwordx4 v33, s[48:51], s72 offen offset:1024  lds
    v_mfma_f32_16x16x32_bf16 v[96:99], v[112:115], v[176:179], v[96:99]
    v_mfma_f32_16x16x32_bf16 v[100:103], v[112:115], v[180:183], v[100:103]
    v_mfma_f32_16x16x32_bf16 v[96:99], v[116:119], v[184:187], v[96:99]
    v_mfma_f32_16x16x32_bf16 v[100:103], v[116:119], v[188:191], v[100:103]
    buffer_load_dwordx4 v34, s[48:51], s72 offen offset:2048  lds
    s_bfe_u32 s3, s87, 196624
    s_lshl_b32 s3, s3, 7
    v_add_u32 v126, s3, v125
    ds_read_b128 v[104:107], v126 offset:0
    ds_read_b128 v[108:111], v126 offset:64
    buffer_load_dwordx4 v35, s[48:51], s72 offen offset:3072  lds
    s_add_u32 m0, s83, 90112
    s_nop 0
    buffer_load_dwordx4 v36, s[52:55], s72 offen offset:0  lds
    buffer_load_dwordx4 v37, s[52:55], s72 offen offset:1024  lds
    s_waitcnt vmcnt(12)
    s_waitcnt lgkmcnt(0)
    s_barrier
    s_add_u32 m0, s86, 122880
    s_bfe_u32 s73, s87, 196612
    s_mul_i32 s73, s73, 176128
    buffer_load_dwordx4 v120, s[56:59], s73 offen offset:0  lds
    ds_read_b128 v[208:211], v44 offset:24576
    ds_read_b128 v[212:215], v44 offset:26624
    ds_read_b128 v[216:219], v45 offset:24576
    ds_read_b128 v[220:223], v45 offset:26624
    buffer_load_dwordx4 v121, s[56:59], s73 offen offset:1024  lds
    v_mfma_f32_16x16x32_bf16 v[96:99], v[104:107], v[192:195], v[96:99]
    v_mfma_f32_16x16x32_bf16 v[100:103], v[104:107], v[196:199], v[100:103]
    v_mfma_f32_16x16x32_bf16 v[96:99], v[108:111], v[200:203], v[96:99]
    v_mfma_f32_16x16x32_bf16 v[100:103], v[108:111], v[204:207], v[100:103]
    buffer_load_dwordx4 v122, s[56:59], s73 offen offset:2048  lds
    s_bfe_u32 s3, s87, 196628
    s_lshl_b32 s3, s3, 7
    v_add_u32 v126, s3, v125
    ds_read_b128 v[112:115], v126 offset:0
    ds_read_b128 v[116:119], v126 offset:64
    s_add_u32 m0, s86, 135168
    s_nop 0
    buffer_load_dwordx4 v120, s[60:63], s73 offen offset:0  lds
    buffer_load_dwordx4 v121, s[60:63], s73 offen offset:1024  lds
    buffer_load_dwordx4 v122, s[60:63], s73 offen offset:2048  lds
    s_add_u32 m0, s26, 48
    s_mov_b64 exec, 1
    buffer_load_dword off, s[28:31], 4 lds
    s_mov_b64 exec, -1
    s_waitcnt vmcnt(13)
    s_waitcnt lgkmcnt(0)
    s_barrier
    s_add_u32 m0, s86, 0
    s_bfe_u32 s73, s87, 196616
    s_mul_i32 s73, s73, 176128
    buffer_load_dwordx4 v120, s[56:59], s73 offen offset:0  lds
    ds_read_b128 v[224:227], v123 offset:0
    ds_read_b128 v[228:231], v123 offset:2048
    ds_read_b128 v[232:235], v124 offset:0
    ds_read_b128 v[236:239], v124 offset:2048
    buffer_load_dwordx4 v121, s[56:59], s73 offen offset:1024  lds
    v_mfma_f32_16x16x32_bf16 v[96:99], v[112:115], v[208:211], v[96:99]
    v_mfma_f32_16x16x32_bf16 v[100:103], v[112:115], v[212:215], v[100:103]
    v_mfma_f32_16x16x32_bf16 v[96:99], v[116:119], v[216:219], v[96:99]
    v_mfma_f32_16x16x32_bf16 v[100:103], v[116:119], v[220:223], v[100:103]
    buffer_load_dwordx4 v122, s[56:59], s73 offen offset:2048  lds
    s_bfe_u32 s3, s87, 196632
    s_lshl_b32 s3, s3, 7
    v_add_u32 v126, s3, v125
    ds_read_b128 v[104:107], v126 offset:0
    ds_read_b128 v[108:111], v126 offset:64
    s_add_u32 m0, s86, 12288
    s_nop 0
    buffer_load_dwordx4 v120, s[60:63], s73 offen offset:0  lds
    buffer_load_dwordx4 v121, s[60:63], s73 offen offset:1024  lds
    buffer_load_dwordx4 v122, s[60:63], s73 offen offset:2048  lds
    s_add_u32 m0, s26, 48
    s_mov_b64 exec, 1
    buffer_load_dword off, s[28:31], 8 lds
    s_mov_b64 exec, -1
    s_waitcnt vmcnt(14)
    s_waitcnt lgkmcnt(0)
    s_barrier
    ds_read_b128 v[240:243], v123 offset:24576
    ds_read_b128 v[244:247], v123 offset:26624
    ds_read_b128 v[248:251], v124 offset:24576
    ds_read_b128 v[252:255], v124 offset:26624
    v_mfma_f32_16x16x32_bf16 v[96:99], v[104:107], v[224:227], v[96:99]
    v_mfma_f32_16x16x32_bf16 v[100:103], v[104:107], v[228:231], v[100:103]
    v_mfma_f32_16x16x32_bf16 v[96:99], v[108:111], v[232:235], v[96:99]
    v_mfma_f32_16x16x32_bf16 v[100:103], v[108:111], v[236:239], v[100:103]
    s_bfe_u32 s3, s87, 196636
    s_lshl_b32 s3, s3, 7
    v_add_u32 v126, s3, v125
    ds_read_b128 v[112:115], v126 offset:0
    ds_read_b128 v[116:119], v126 offset:64
    s_waitcnt lgkmcnt(0)
    ds_read_b64_tr_b16 v[8:9], v2 offset:0
    ds_read_b64_tr_b16 v[10:11], v2 offset:768
    ds_read_b64_tr_b16 v[12:13], v3 offset:0
    ds_read_b64_tr_b16 v[14:15], v3 offset:768
    ds_read_b64_tr_b16 v[16:17], v2 offset:12288
    ds_read_b64_tr_b16 v[18:19], v2 offset:13056
    ds_read_b64_tr_b16 v[20:21], v3 offset:12288
    ds_read_b64_tr_b16 v[22:23], v3 offset:13056
    ds_read_b64_tr_b16 v[24:25], v2 offset:64
    ds_read_b64_tr_b16 v[26:27], v2 offset:832
    s_setprio 2
    s_waitcnt lgkmcnt(6)
    v_mfma_f32_16x16x32_bf16 v[32:35], v[8:11], v[128:131], 0
    ds_read_b64_tr_b16 v[28:29], v3 offset:64
    v_mfma_f32_16x16x32_bf16 v[40:43], v[8:11], v[132:135], 0
    ds_read_b64_tr_b16 v[30:31], v3 offset:832
    v_mfma_f32_16x16x32_bf16 v[36:39], v[12:15], v[128:131], 0
    ds_read_b64_tr_b16 v[8:9], v2 offset:12352
    v_mfma_f32_16x16x32_bf16 v[96:99], v[112:115], v[240:243], v[96:99]
    v_mfma_f32_16x16x32_bf16 v[100:103], v[112:115], v[244:247], v[100:103]
    v_mfma_f32_16x16x32_bf16 v[96:99], v[116:119], v[248:251], v[96:99]
    v_mfma_f32_16x16x32_bf16 v[100:103], v[116:119], v[252:255], v[100:103]
    s_mov_b32 vcc_lo, 0xffff0000
    s_mov_b32 vcc_hi, 0xffff0000
    v_mfma_f32_16x16x32_bf16 v[44:47], v[12:15], v[132:135], 0
    ds_read_b64_tr_b16 v[10:11], v2 offset:13120
    s_waitcnt lgkmcnt(6)
    v_mfma_f32_16x16x32_bf16 v[48:51], v[16:19], v[128:131], 0
    ds_read_b64_tr_b16 v[12:13], v3 offset:12352
    v_mfma_f32_16x16x32_bf16 v[56:59], v[16:19], v[132:135], 0
    ds_read_b64_tr_b16 v[14:15], v3 offset:13120
    v_mfma_f32_16x16x32_bf16 v[52:55], v[20:23], v[128:131], 0
    ds_read_b64_tr_b16 v[16:17], v2 offset:6144
    v_cndmask_b32 v96, v96, v100, vcc
    v_mfma_f32_16x16x32_bf16 v[60:63], v[20:23], v[132:135], 0
    ds_read_b64_tr_b16 v[18:19], v2 offset:6912
    s_waitcnt lgkmcnt(6)
    v_mfma_f32_16x16x32_bf16 v[64:67], v[24:27], v[128:131], 0
    ds_read_b64_tr_b16 v[20:21], v3 offset:6144
    ds_write_b32 v127, v96
    v_mfma_f32_16x16x32_bf16 v[72:75], v[24:27], v[132:135], 0
    ds_read_b64_tr_b16 v[22:23], v3 offset:6912
    v_mfma_f32_16x16x32_bf16 v[68:71], v[28:31], v[128:131], 0
    ds_read_b64_tr_b16 v[24:25], v2 offset:18432
    v_mfma_f32_16x16x32_bf16 v[76:79], v[28:31], v[132:135], 0
    ds_read_b64_tr_b16 v[26:27], v2 offset:19200
    s_waitcnt lgkmcnt(7)
    v_mfma_f32_16x16x32_bf16 v[80:83], v[8:11], v[128:131], 0
    ds_read_b64_tr_b16 v[28:29], v3 offset:18432
    v_mfma_f32_16x16x32_bf16 v[88:91], v[8:11], v[132:135], 0
    ds_read_b64_tr_b16 v[30:31], v3 offset:19200
    v_mfma_f32_16x16x32_bf16 v[84:87], v[12:15], v[128:131], 0
    ds_read_b64_tr_b16 v[8:9], v2 offset:6208
    v_mfma_f32_16x16x32_bf16 v[92:95], v[12:15], v[132:135], 0
    ds_read_b64_tr_b16 v[10:11], v2 offset:6976
    s_waitcnt lgkmcnt(6)
    v_mfma_f32_16x16x32_bf16 v[32:35], v[16:19], v[136:139], v[32:35]
    ds_read_b64_tr_b16 v[12:13], v3 offset:6208
    v_mfma_f32_16x16x32_bf16 v[40:43], v[16:19], v[140:143], v[40:43]
    ds_read_b64_tr_b16 v[14:15], v3 offset:6976
    v_mfma_f32_16x16x32_bf16 v[36:39], v[20:23], v[136:139], v[36:39]
    ds_read_b64_tr_b16 v[16:17], v2 offset:18496
    v_mfma_f32_16x16x32_bf16 v[44:47], v[20:23], v[140:143], v[44:47]
    ds_read_b64_tr_b16 v[18:19], v2 offset:19264
    s_waitcnt lgkmcnt(6)
    v_mfma_f32_16x16x32_bf16 v[48:51], v[24:27], v[136:139], v[48:51]
    ds_read_b64_tr_b16 v[20:21], v3 offset:18496
    s_add_u32 m0, s26, 0
    s_mov_b64 exec, 1
    buffer_load_dword off, s[28:31], 4 lds
    s_mov_b64 exec, -1
    v_mfma_f32_16x16x32_bf16 v[56:59], v[24:27], v[140:143], v[56:59]
    ds_read_b64_tr_b16 v[22:23], v3 offset:19264
    v_mfma_f32_16x16x32_bf16 v[52:55], v[28:31], v[136:139], v[52:55]
    ds_read_b64_tr_b16 v[24:25], v2 offset:128
    v_mfma_f32_16x16x32_bf16 v[60:63], v[28:31], v[140:143], v[60:63]
    ds_read_b64_tr_b16 v[26:27], v2 offset:896
    s_waitcnt lgkmcnt(6)
    v_mfma_f32_16x16x32_bf16 v[64:67], v[8:11], v[136:139], v[64:67]
    ds_read_b64_tr_b16 v[28:29], v3 offset:128
    v_mfma_f32_16x16x32_bf16 v[72:75], v[8:11], v[140:143], v[72:75]
    ds_read_b64_tr_b16 v[30:31], v3 offset:896
    v_mfma_f32_16x16x32_bf16 v[68:71], v[12:15], v[136:139], v[68:71]
    ds_read_b64_tr_b16 v[8:9], v2 offset:12416
    v_mfma_f32_16x16x32_bf16 v[76:79], v[12:15], v[140:143], v[76:79]
    ds_read_b64_tr_b16 v[10:11], v2 offset:13184
    s_waitcnt lgkmcnt(6)
    v_mfma_f32_16x16x32_bf16 v[80:83], v[16:19], v[136:139], v[80:83]
    ds_read_b64_tr_b16 v[12:13], v3 offset:12416
    ds_read_b32 v6, v5 offset:48
    v_mfma_f32_16x16x32_bf16 v[88:91], v[16:19], v[140:143], v[88:91]
    ds_read_b64_tr_b16 v[14:15], v3 offset:13184
    v_mfma_f32_16x16x32_bf16 v[84:87], v[20:23], v[136:139], v[84:87]
    ds_read_b64_tr_b16 v[16:17], v2 offset:6272
    v_mfma_f32_16x16x32_bf16 v[92:95], v[20:23], v[140:143], v[92:95]
    ds_read_b64_tr_b16 v[18:19], v2 offset:7040
    s_waitcnt lgkmcnt(7)
    v_mfma_f32_16x16x32_bf16 v[96:99], v[24:27], v[128:131], 0
    ds_read_b64_tr_b16 v[20:21], v3 offset:6272
    v_mfma_f32_16x16x32_bf16 v[104:107], v[24:27], v[132:135], 0
    ds_read_b64_tr_b16 v[22:23], v3 offset:7040
    v_mfma_f32_16x16x32_bf16 v[100:103], v[28:31], v[128:131], 0
    ds_read_b64_tr_b16 v[24:25], v2 offset:18560
    v_mfma_f32_16x16x32_bf16 v[108:111], v[28:31], v[132:135], 0
    ds_read_b64_tr_b16 v[26:27], v2 offset:19328
    s_waitcnt lgkmcnt(6)
    v_mfma_f32_16x16x32_bf16 v[112:115], v[8:11], v[128:131], 0
    ds_read_b64_tr_b16 v[28:29], v3 offset:18560
    v_cmp_gt_u32 vcc, 1, v6
    v_mfma_f32_16x16x32_bf16 v[120:123], v[8:11], v[132:135], 0
    ds_read_b64_tr_b16 v[30:31], v3 offset:19328
    v_mfma_f32_16x16x32_bf16 v[116:119], v[12:15], v[128:131], 0
    s_cbranch_vccnz L_slow1
L_back1:
    ds_read_b64_tr_b16 v[8:9], v2 offset:24576
    v_mfma_f32_16x16x32_bf16 v[124:127], v[12:15], v[132:135], 0
    ds_read_b64_tr_b16 v[10:11], v2 offset:25344
    s_waitcnt lgkmcnt(6)
    v_mfma_f32_16x16x32_bf16 v[96:99], v[16:19], v[136:139], v[96:99]
    ds_read_b64_tr_b16 v[12:13], v3 offset:24576
    v_mfma_f32_16x16x32_bf16 v[104:107], v[16:19], v[140:143], v[104:107]
    ds_read_b64_tr_b16 v[14:15], v3 offset:25344
    v_mfma_f32_16x16x32_bf16 v[100:103], v[20:23], v[136:139], v[100:103]
    ds_read_b64_tr_b16 v[16:17], v2 offset:36864
    v_mfma_f32_16x16x32_bf16 v[108:111], v[20:23], v[140:143], v[108:111]
    ds_read_b64_tr_b16 v[18:19], v2 offset:37632
    s_waitcnt lgkmcnt(6)
    v_mfma_f32_16x16x32_bf16 v[112:115], v[24:27], v[136:139], v[112:115]
    ds_read_b64_tr_b16 v[20:21], v3 offset:36864
    v_mfma_f32_16x16x32_bf16 v[120:123], v[24:27], v[140:143], v[120:123]
    ds_read_b64_tr_b16 v[22:23], v3 offset:37632
    v_mfma_f32_16x16x32_bf16 v[116:119], v[28:31], v[136:139], v[116:119]
    ds_read_b64_tr_b16 v[24:25], v2 offset:24640
    v_mfma_f32_16x16x32_bf16 v[124:127], v[28:31], v[140:143], v[124:127]
    ds_read_b64_tr_b16 v[26:27], v2 offset:25408
    s_waitcnt lgkmcnt(6)
    v_mfma_f32_16x16x32_bf16 v[32:35], v[8:11], v[144:147], v[32:35]
    ds_read_b64_tr_b16 v[28:29], v3 offset:24640
    v_mfma_f32_16x16x32_bf16 v[40:43], v[8:11], v[148:151], v[40:43]
    ds_read_b64_tr_b16 v[30:31], v3 offset:25408
    v_mfma_f32_16x16x32_bf16 v[36:39], v[12:15], v[144:147], v[36:39]
    ds_read_b64_tr_b16 v[8:9], v2 offset:36928
    s_mov_b64 exec, 1
    buffer_load_dword off, s[28:31], 8 lds
    s_mov_b64 exec, -1
    v_mfma_f32_16x16x32_bf16 v[44:47], v[12:15], v[148:151], v[44:47]
    ds_read_b64_tr_b16 v[10:11], v2 offset:37696
    s_waitcnt lgkmcnt(6)
    v_mfma_f32_16x16x32_bf16 v[48:51], v[16:19], v[144:147], v[48:51]
    ds_read_b64_tr_b16 v[12:13], v3 offset:36928
    v_mfma_f32_16x16x32_bf16 v[56:59], v[16:19], v[148:151], v[56:59]
    ds_read_b64_tr_b16 v[14:15], v3 offset:37696
    v_mfma_f32_16x16x32_bf16 v[52:55], v[20:23], v[144:147], v[52:55]
    ds_read_b64_tr_b16 v[16:17], v2 offset:24704
    v_mfma_f32_16x16x32_bf16 v[60:63], v[20:23], v[148:151], v[60:63]
    ds_read_b64_tr_b16 v[18:19], v2 offset:25472
    s_waitcnt lgkmcnt(6)
    v_mfma_f32_16x16x32_bf16 v[64:67], v[24:27], v[144:147], v[64:67]
    ds_read_b64_tr_b16 v[20:21], v3 offset:24704
    v_mfma_f32_16x16x32_bf16 v[72:75], v[24:27], v[148:151], v[72:75]
    ds_read_b64_tr_b16 v[22:23], v3 offset:25472
    v_mfma_f32_16x16x32_bf16 v[68:71], v[28:31], v[144:147], v[68:71]
    ds_read_b64_tr_b16 v[24:25], v2 offset:36992
    v_mfma_f32_16x16x32_bf16 v[76:79], v[28:31], v[148:151], v[76:79]
    ds_read_b64_tr_b16 v[26:27], v2 offset:37760
    s_waitcnt lgkmcnt(6)
    v_mfma_f32_16x16x32_bf16 v[80:83], v[8:11], v[144:147], v[80:83]
    ds_read_b64_tr_b16 v[28:29], v3 offset:36992
    v_mfma_f32_16x16x32_bf16 v[88:91], v[8:11], v[148:151], v[88:91]
    ds_read_b64_tr_b16 v[30:31], v3 offset:37760
    v_mfma_f32_16x16x32_bf16 v[84:87], v[12:15], v[144:147], v[84:87]
    ds_read_b64_tr_b16 v[8:9], v2 offset:30720
    v_mfma_f32_16x16x32_bf16 v[92:95], v[12:15], v[148:151], v[92:95]
    ds_read_b64_tr_b16 v[10:11], v2 offset:31488
    s_waitcnt lgkmcnt(6)
    v_mfma_f32_16x16x32_bf16 v[96:99], v[16:19], v[144:147], v[96:99]
    ds_read_b64_tr_b16 v[12:13], v3 offset:30720
    v_mfma_f32_16x16x32_bf16 v[104:107], v[16:19], v[148:151], v[104:107]
    ds_read_b64_tr_b16 v[14:15], v3 offset:31488
    v_mfma_f32_16x16x32_bf16 v[100:103], v[20:23], v[144:147], v[100:103]
    ds_read_b64_tr_b16 v[16:17], v2 offset:43008
    v_mfma_f32_16x16x32_bf16 v[108:111], v[20:23], v[148:151], v[108:111]
    ds_read_b64_tr_b16 v[18:19], v2 offset:43776
    s_waitcnt lgkmcnt(6)
    v_mfma_f32_16x16x32_bf16 v[112:115], v[24:27], v[144:147], v[112:115]
    ds_read_b64_tr_b16 v[20:21], v3 offset:43008
    v_mfma_f32_16x16x32_bf16 v[120:123], v[24:27], v[148:151], v[120:123]
    ds_read_b64_tr_b16 v[22:23], v3 offset:43776
    v_mfma_f32_16x16x32_bf16 v[116:119], v[28:31], v[144:147], v[116:119]
    ds_read_b64_tr_b16 v[24:25], v2 offset:30784
    ds_read_b32 v6, v5 offset:48
    v_mfma_f32_16x16x32_bf16 v[124:127], v[28:31], v[148:151], v[124:127]
    ds_read_b64_tr_b16 v[26:27], v2 offset:31552
    s_waitcnt lgkmcnt(7)
    v_mfma_f32_16x16x32_bf16 v[32:35], v[8:11], v[152:155], v[32:35]
    ds_read_b64_tr_b16 v[28:29], v3 offset:30784
    v_mfma_f32_16x16x32_bf16 v[40:43], v[8:11], v[156:159], v[40:43]
    ds_read_b64_tr_b16 v[30:31], v3 offset:31552
    v_mfma_f32_16x16x32_bf16 v[36:39], v[12:15], v[152:155], v[36:39]
    ds_read_b64_tr_b16 v[8:9], v2 offset:43072
    v_mfma_f32_16x16x32_bf16 v[44:47], v[12:15], v[156:159], v[44:47]
    ds_read_b64_tr_b16 v[10:11], v2 offset:43840
    s_waitcnt lgkmcnt(7)
    v_mfma_f32_16x16x32_bf16 v[48:51], v[16:19], v[152:155], v[48:51]
    ds_read_b64_tr_b16 v[12:13], v3 offset:43072
    v_mfma_f32_16x16x32_bf16 v[56:59], v[16:19], v[156:159], v[56:59]
    ds_read_b64_tr_b16 v[14:15], v3 offset:43840
    v_mfma_f32_16x16x32_bf16 v[52:55], v[20:23], v[152:155], v[52:55]
    ds_read_b64_tr_b16 v[16:17], v2 offset:30848
    v_mfma_f32_16x16x32_bf16 v[60:63], v[20:23], v[156:159], v[60:63]
    ds_read_b64_tr_b16 v[18:19], v2 offset:31616
    s_waitcnt lgkmcnt(6)
    v_mfma_f32_16x16x32_bf16 v[64:67], v[24:27], v[152:155], v[64:67]
    ds_read_b64_tr_b16 v[20:21], v3 offset:30848
    v_mfma_f32_16x16x32_bf16 v[72:75], v[24:27], v[156:159], v[72:75]
    ds_read_b64_tr_b16 v[22:23], v3 offset:31616
    v_mfma_f32_16x16x32_bf16 v[68:71], v[28:31], v[152:155], v[68:71]
    ds_read_b64_tr_b16 v[24:25], v2 offset:43136
    v_mfma_f32_16x16x32_bf16 v[76:79], v[28:31], v[156:159], v[76:79]
    ds_read_b64_tr_b16 v[26:27], v2 offset:43904
    s_waitcnt lgkmcnt(6)
    v_mfma_f32_16x16x32_bf16 v[80:83], v[8:11], v[152:155], v[80:83]
    ds_read_b64_tr_b16 v[28:29], v3 offset:43136
    v_cmp_gt_u32 vcc, 2, v6
    v_mfma_f32_16x16x32_bf16 v[88:91], v[8:11], v[156:159], v[88:91]
    ds_read_b64_tr_b16 v[30:31], v3 offset:43904
    v_mfma_f32_16x16x32_bf16 v[84:87], v[12:15], v[152:155], v[84:87]
    s_cbranch_vccnz L_slow2
L_back2:
    ds_read_b64_tr_b16 v[8:9], v0 offset:0
    v_mfma_f32_16x16x32_bf16 v[92:95], v[12:15], v[156:159], v[92:95]
    ds_read_b64_tr_b16 v[10:11], v0 offset:768
    s_waitcnt lgkmcnt(6)
    v_mfma_f32_16x16x32_bf16 v[96:99], v[16:19], v[152:155], v[96:99]
    ds_read_b64_tr_b16 v[12:13], v1 offset:0
    v_mfma_f32_16x16x32_bf16 v[104:107], v[16:19], v[156:159], v[104:107]
    ds_read_b64_tr_b16 v[14:15], v1 offset:768
    v_mfma_f32_16x16x32_bf16 v[100:103], v[20:23], v[152:155], v[100:103]
    ds_read_b64_tr_b16 v[16:17], v0 offset:12288
    v_mfma_f32_16x16x32_bf16 v[108:111], v[20:23], v[156:159], v[108:111]
    ds_read_b64_tr_b16 v[18:19], v0 offset:13056
    s_waitcnt lgkmcnt(6)
    v_mfma_f32_16x16x32_bf16 v[112:115], v[24:27], v[152:155], v[112:115]
    ds_read_b64_tr_b16 v[20:21], v1 offset:12288
    v_mfma_f32_16x16x32_bf16 v[120:123], v[24:27], v[156:159], v[120:123]
    ds_read_b64_tr_b16 v[22:23], v1 offset:13056
    v_mfma_f32_16x16x32_bf16 v[116:119], v[28:31], v[152:155], v[116:119]
    ds_read_b64_tr_b16 v[24:25], v0 offset:64
    v_mfma_f32_16x16x32_bf16 v[124:127], v[28:31], v[156:159], v[124:127]
    ds_read_b64_tr_b16 v[26:27], v0 offset:832
    s_waitcnt lgkmcnt(6)
    v_mfma_f32_16x16x32_bf16 v[32:35], v[8:11], v[160:163], v[32:35]
    ds_read_b64_tr_b16 v[28:29], v1 offset:64
    v_mfma_f32_16x16x32_bf16 v[40:43], v[8:11], v[164:167], v[40:43]
    ds_read_b64_tr_b16 v[30:31], v1 offset:832
    v_mfma_f32_16x16x32_bf16 v[36:39], v[12:15], v[160:163], v[36:39]
    ds_read_b64_tr_b16 v[8:9], v0 offset:12352
    s_mov_b64 exec, 1
    buffer_load_dword off, s[28:31], 12 lds
    s_mov_b64 exec, -1
    v_mfma_f32_16x16x32_bf16 v[44:47], v[12:15], v[164:167], v[44:47]
    ds_read_b64_tr_b16 v[10:11], v0 offset:13120
    s_waitcnt lgkmcnt(6)
    v_mfma_f32_16x16x32_bf16 v[48:51], v[16:19], v[160:163], v[48:51]
    ds_read_b64_tr_b16 v[12:13], v1 offset:12352
    v_mfma_f32_16x16x32_bf16 v[56:59], v[16:19], v[164:167], v[56:59]
    ds_read_b64_tr_b16 v[14:15], v1 offset:13120
    v_mfma_f32_16x16x32_bf16 v[52:55], v[20:23], v[160:163], v[52:55]
    ds_read_b64_tr_b16 v[16:17], v0 offset:128
    v_mfma_f32_16x16x32_bf16 v[60:63], v[20:23], v[164:167], v[60:63]
    ds_read_b64_tr_b16 v[18:19], v0 offset:896
    s_waitcnt lgkmcnt(6)
    v_mfma_f32_16x16x32_bf16 v[64:67], v[24:27], v[160:163], v[64:67]
    ds_read_b64_tr_b16 v[20:21], v1 offset:128
    v_mfma_f32_16x16x32_bf16 v[72:75], v[24:27], v[164:167], v[72:75]
    ds_read_b64_tr_b16 v[22:23], v1 offset:896
    v_mfma_f32_16x16x32_bf16 v[68:71], v[28:31], v[160:163], v[68:71]
    ds_read_b64_tr_b16 v[24:25], v0 offset:12416
    v_mfma_f32_16x16x32_bf16 v[76:79], v[28:31], v[164:167], v[76:79]
    ds_read_b64_tr_b16 v[26:27], v0 offset:13184
    s_waitcnt lgkmcnt(6)
    v_mfma_f32_16x16x32_bf16 v[80:83], v[8:11], v[160:163], v[80:83]
    ds_read_b64_tr_b16 v[28:29], v1 offset:12416
    v_mfma_f32_16x16x32_bf16 v[88:91], v[8:11], v[164:167], v[88:91]
    ds_read_b64_tr_b16 v[30:31], v1 offset:13184
    v_mfma_f32_16x16x32_bf16 v[84:87], v[12:15], v[160:163], v[84:87]
    ds_read_b64_tr_b16 v[8:9], v0 offset:6144
    v_mfma_f32_16x16x32_bf16 v[92:95], v[12:15], v[164:167], v[92:95]
    ds_read_b64_tr_b16 v[10:11], v0 offset:6912
    s_waitcnt lgkmcnt(6)
    v_mfma_f32_16x16x32_bf16 v[96:99], v[16:19], v[160:163], v[96:99]
    ds_read_b64_tr_b16 v[12:13], v1 offset:6144
    v_mfma_f32_16x16x32_bf16 v[104:107], v[16:19], v[164:167], v[104:107]
    ds_read_b64_tr_b16 v[14:15], v1 offset:6912
    v_mfma_f32_16x16x32_bf16 v[100:103], v[20:23], v[160:163], v[100:103]
    ds_read_b64_tr_b16 v[16:17], v0 offset:18432
    v_mfma_f32_16x16x32_bf16 v[108:111], v[20:23], v[164:167], v[108:111]
    ds_read_b64_tr_b16 v[18:19], v0 offset:19200
    s_waitcnt lgkmcnt(6)
    v_mfma_f32_16x16x32_bf16 v[112:115], v[24:27], v[160:163], v[112:115]
    ds_read_b64_tr_b16 v[20:21], v1 offset:18432
    v_mfma_f32_16x16x32_bf16 v[120:123], v[24:27], v[164:167], v[120:123]
    ds_read_b64_tr_b16 v[22:23], v1 offset:19200
    v_mfma_f32_16x16x32_bf16 v[116:119], v[28:31], v[160:163], v[116:119]
    ds_read_b64_tr_b16 v[24:25], v0 offset:6208
    ds_read_b32 v6, v5 offset:16
    v_mfma_f32_16x16x32_bf16 v[124:127], v[28:31], v[164:167], v[124:127]
    ds_read_b64_tr_b16 v[26:27], v0 offset:6976
    s_waitcnt lgkmcnt(7)
    v_mfma_f32_16x16x32_bf16 v[32:35], v[8:11], v[168:171], v[32:35]
    ds_read_b64_tr_b16 v[28:29], v1 offset:6208
    v_mfma_f32_16x16x32_bf16 v[40:43], v[8:11], v[172:175], v[40:43]
    ds_read_b64_tr_b16 v[30:31], v1 offset:6976
    v_mfma_f32_16x16x32_bf16 v[36:39], v[12:15], v[168:171], v[36:39]
    ds_read_b64_tr_b16 v[8:9], v0 offset:18496
    v_mfma_f32_16x16x32_bf16 v[44:47], v[12:15], v[172:175], v[44:47]
    ds_read_b64_tr_b16 v[10:11], v0 offset:19264
    s_waitcnt lgkmcnt(7)
    v_mfma_f32_16x16x32_bf16 v[48:51], v[16:19], v[168:171], v[48:51]
    ds_read_b64_tr_b16 v[12:13], v1 offset:18496
    v_mfma_f32_16x16x32_bf16 v[56:59], v[16:19], v[172:175], v[56:59]
    ds_read_b64_tr_b16 v[14:15], v1 offset:19264
    v_mfma_f32_16x16x32_bf16 v[52:55], v[20:23], v[168:171], v[52:55]
    ds_read_b64_tr_b16 v[16:17], v0 offset:6272
    v_mfma_f32_16x16x32_bf16 v[60:63], v[20:23], v[172:175], v[60:63]
    ds_read_b64_tr_b16 v[18:19], v0 offset:7040
    s_waitcnt lgkmcnt(6)
    v_mfma_f32_16x16x32_bf16 v[64:67], v[24:27], v[168:171], v[64:67]
    ds_read_b64_tr_b16 v[20:21], v1 offset:6272
    v_mfma_f32_16x16x32_bf16 v[72:75], v[24:27], v[172:175], v[72:75]
    ds_read_b64_tr_b16 v[22:23], v1 offset:7040
    v_mfma_f32_16x16x32_bf16 v[68:71], v[28:31], v[168:171], v[68:71]
    ds_read_b64_tr_b16 v[24:25], v0 offset:18560
    v_mfma_f32_16x16x32_bf16 v[76:79], v[28:31], v[172:175], v[76:79]
    ds_read_b64_tr_b16 v[26:27], v0 offset:19328
    s_waitcnt lgkmcnt(6)
    v_mfma_f32_16x16x32_bf16 v[80:83], v[8:11], v[168:171], v[80:83]
    ds_read_b64_tr_b16 v[28:29], v1 offset:18560
    v_cmp_gt_u32 vcc, 3, v6
    v_mfma_f32_16x16x32_bf16 v[88:91], v[8:11], v[172:175], v[88:91]
    ds_read_b64_tr_b16 v[30:31], v1 offset:19328
    v_mfma_f32_16x16x32_bf16 v[84:87], v[12:15], v[168:171], v[84:87]
    s_cbranch_vccnz L_slow3
L_back3:
    ds_read_b64_tr_b16 v[8:9], v0 offset:24576
    v_mfma_f32_16x16x32_bf16 v[92:95], v[12:15], v[172:175], v[92:95]
    ds_read_b64_tr_b16 v[10:11], v0 offset:25344
    s_waitcnt lgkmcnt(6)
    v_mfma_f32_16x16x32_bf16 v[96:99], v[16:19], v[168:171], v[96:99]
    ds_read_b64_tr_b16 v[12:13], v1 offset:24576
    v_mfma_f32_16x16x32_bf16 v[104:107], v[16:19], v[172:175], v[104:107]
    ds_read_b64_tr_b16 v[14:15], v1 offset:25344
    v_mfma_f32_16x16x32_bf16 v[100:103], v[20:23], v[168:171], v[100:103]
    ds_read_b64_tr_b16 v[16:17], v0 offset:36864
    v_mfma_f32_16x16x32_bf16 v[108:111], v[20:23], v[172:175], v[108:111]
    ds_read_b64_tr_b16 v[18:19], v0 offset:37632
    s_waitcnt lgkmcnt(6)
    v_mfma_f32_16x16x32_bf16 v[112:115], v[24:27], v[168:171], v[112:115]
    ds_read_b64_tr_b16 v[20:21], v1 offset:36864
    v_mfma_f32_16x16x32_bf16 v[120:123], v[24:27], v[172:175], v[120:123]
    ds_read_b64_tr_b16 v[22:23], v1 offset:37632
    v_mfma_f32_16x16x32_bf16 v[116:119], v[28:31], v[168:171], v[116:119]
    ds_read_b64_tr_b16 v[24:25], v0 offset:24640
    v_mfma_f32_16x16x32_bf16 v[124:127], v[28:31], v[172:175], v[124:127]
    ds_read_b64_tr_b16 v[26:27], v0 offset:25408
    s_waitcnt lgkmcnt(6)
    v_mfma_f32_16x16x32_bf16 v[32:35], v[8:11], v[176:179], v[32:35]
    ds_read_b64_tr_b16 v[28:29], v1 offset:24640
    v_mfma_f32_16x16x32_bf16 v[40:43], v[8:11], v[180:183], v[40:43]
    ds_read_b64_tr_b16 v[30:31], v1 offset:25408
    v_mfma_f32_16x16x32_bf16 v[36:39], v[12:15], v[176:179], v[36:39]
    ds_read_b64_tr_b16 v[8:9], v0 offset:36928
    s_mov_b64 exec, 1
    buffer_load_dword off, s[28:31], 16 lds
    s_mov_b64 exec, -1
    v_mfma_f32_16x16x32_bf16 v[44:47], v[12:15], v[180:183], v[44:47]
    ds_read_b64_tr_b16 v[10:11], v0 offset:37696
    s_waitcnt lgkmcnt(6)
    v_mfma_f32_16x16x32_bf16 v[48:51], v[16:19], v[176:179], v[48:51]
    ds_read_b64_tr_b16 v[12:13], v1 offset:36928
    v_mfma_f32_16x16x32_bf16 v[56:59], v[16:19], v[180:183], v[56:59]
    ds_read_b64_tr_b16 v[14:15], v1 offset:37696
    v_mfma_f32_16x16x32_bf16 v[52:55], v[20:23], v[176:179], v[52:55]
    ds_read_b64_tr_b16 v[16:17], v0 offset:24704
    v_mfma_f32_16x16x32_bf16 v[60:63], v[20:23], v[180:183], v[60:63]
    ds_read_b64_tr_b16 v[18:19], v0 offset:25472
    s_waitcnt lgkmcnt(6)
    v_mfma_f32_16x16x32_bf16 v[64:67], v[24:27], v[176:179], v[64:67]
    ds_read_b64_tr_b16 v[20:21], v1 offset:24704
    v_mfma_f32_16x16x32_bf16 v[72:75], v[24:27], v[180:183], v[72:75]
    ds_read_b64_tr_b16 v[22:23], v1 offset:25472
    v_mfma_f32_16x16x32_bf16 v[68:71], v[28:31], v[176:179], v[68:71]
    ds_read_b64_tr_b16 v[24:25], v0 offset:36992
    v_mfma_f32_16x16x32_bf16 v[76:79], v[28:31], v[180:183], v[76:79]
    ds_read_b64_tr_b16 v[26:27], v0 offset:37760
    s_waitcnt lgkmcnt(6)
    v_mfma_f32_16x16x32_bf16 v[80:83], v[8:11], v[176:179], v[80:83]
    ds_read_b64_tr_b16 v[28:29], v1 offset:36992
    v_mfma_f32_16x16x32_bf16 v[88:91], v[8:11], v[180:183], v[88:91]
    ds_read_b64_tr_b16 v[30:31], v1 offset:37760
    v_mfma_f32_16x16x32_bf16 v[84:87], v[12:15], v[176:179], v[84:87]
    ds_read_b64_tr_b16 v[8:9], v0 offset:30720
    v_mfma_f32_16x16x32_bf16 v[92:95], v[12:15], v[180:183], v[92:95]
    ds_read_b64_tr_b16 v[10:11], v0 offset:31488
    s_waitcnt lgkmcnt(6)
    v_mfma_f32_16x16x32_bf16 v[96:99], v[16:19], v[176:179], v[96:99]
    ds_read_b64_tr_b16 v[12:13], v1 offset:30720
    v_mfma_f32_16x16x32_bf16 v[104:107], v[16:19], v[180:183], v[104:107]
    ds_read_b64_tr_b16 v[14:15], v1 offset:31488
    v_mfma_f32_16x16x32_bf16 v[100:103], v[20:23], v[176:179], v[100:103]
    ds_read_b64_tr_b16 v[16:17], v0 offset:43008
    v_mfma_f32_16x16x32_bf16 v[108:111], v[20:23], v[180:183], v[108:111]
    ds_read_b64_tr_b16 v[18:19], v0 offset:43776
    s_waitcnt lgkmcnt(6)
    v_mfma_f32_16x16x32_bf16 v[112:115], v[24:27], v[176:179], v[112:115]
    ds_read_b64_tr_b16 v[20:21], v1 offset:43008
    v_mfma_f32_16x16x32_bf16 v[120:123], v[24:27], v[180:183], v[120:123]
    ds_read_b64_tr_b16 v[22:23], v1 offset:43776
    v_mfma_f32_16x16x32_bf16 v[116:119], v[28:31], v[176:179], v[116:119]
    ds_read_b64_tr_b16 v[24:25], v0 offset:30784
    ds_read_b32 v6, v5 offset:16
    v_mfma_f32_16x16x32_bf16 v[124:127], v[28:31], v[180:183], v[124:127]
    ds_read_b64_tr_b16 v[26:27], v0 offset:31552
    s_waitcnt lgkmcnt(7)
    v_mfma_f32_16x16x32_bf16 v[32:35], v[8:11], v[184:187], v[32:35]
    ds_read_b64_tr_b16 v[28:29], v1 offset:30784
    v_mfma_f32_16x16x32_bf16 v[40:43], v[8:11], v[188:191], v[40:43]
    ds_read_b64_tr_b16 v[30:31], v1 offset:31552
    v_mfma_f32_16x16x32_bf16 v[36:39], v[12:15], v[184:187], v[36:39]
    ds_read_b64_tr_b16 v[8:9], v0 offset:43072
    v_mfma_f32_16x16x32_bf16 v[44:47], v[12:15], v[188:191], v[44:47]
    ds_read_b64_tr_b16 v[10:11], v0 offset:43840
    s_waitcnt lgkmcnt(7)
    v_mfma_f32_16x16x32_bf16 v[48:51], v[16:19], v[184:187], v[48:51]
    ds_read_b64_tr_b16 v[12:13], v1 offset:43072
    v_mfma_f32_16x16x32_bf16 v[56:59], v[16:19], v[188:191], v[56:59]
    ds_read_b64_tr_b16 v[14:15], v1 offset:43840
    v_mfma_f32_16x16x32_bf16 v[52:55], v[20:23], v[184:187], v[52:55]
    ds_read_b64_tr_b16 v[16:17], v0 offset:30848
    v_mfma_f32_16x16x32_bf16 v[60:63], v[20:23], v[188:191], v[60:63]
    ds_read_b64_tr_b16 v[18:19], v0 offset:31616
    s_waitcnt lgkmcnt(6)
    v_mfma_f32_16x16x32_bf16 v[64:67], v[24:27], v[184:187], v[64:67]
    ds_read_b64_tr_b16 v[20:21], v1 offset:30848
    v_mfma_f32_16x16x32_bf16 v[72:75], v[24:27], v[188:191], v[72:75]
    ds_read_b64_tr_b16 v[22:23], v1 offset:31616
    v_mfma_f32_16x16x32_bf16 v[68:71], v[28:31], v[184:187], v[68:71]
    ds_read_b64_tr_b16 v[24:25], v0 offset:43136
    v_mfma_f32_16x16x32_bf16 v[76:79], v[28:31], v[188:191], v[76:79]
    ds_read_b64_tr_b16 v[26:27], v0 offset:43904
    s_waitcnt lgkmcnt(6)
    v_mfma_f32_16x16x32_bf16 v[80:83], v[8:11], v[184:187], v[80:83]
    ds_read_b64_tr_b16 v[28:29], v1 offset:43136
    v_cmp_gt_u32 vcc, 4, v6
    v_mfma_f32_16x16x32_bf16 v[88:91], v[8:11], v[188:191], v[88:91]
    ds_read_b64_tr_b16 v[30:31], v1 offset:43904
    v_mfma_f32_16x16x32_bf16 v[84:87], v[12:15], v[184:187], v[84:87]
    s_cbranch_vccnz L_slow4
L_back4:
    v_add_u32 v0, 49152, v0
    v_add_u32 v1, 49152, v1
    ds_read_b64_tr_b16 v[8:9], v0 offset:0
    v_mfma_f32_16x16x32_bf16 v[92:95], v[12:15], v[188:191], v[92:95]
    ds_read_b64_tr_b16 v[10:11], v0 offset:768
    s_waitcnt lgkmcnt(6)
    v_mfma_f32_16x16x32_bf16 v[96:99], v[16:19], v[184:187], v[96:99]
    ds_read_b64_tr_b16 v[12:13], v1 offset:0
    v_mfma_f32_16x16x32_bf16 v[104:107], v[16:19], v[188:191], v[104:107]
    ds_read_b64_tr_b16 v[14:15], v1 offset:768
    v_mfma_f32_16x16x32_bf16 v[100:103], v[20:23], v[184:187], v[100:103]
    ds_read_b64_tr_b16 v[16:17], v0 offset:12288
    v_mfma_f32_16x16x32_bf16 v[108:111], v[20:23], v[188:191], v[108:111]
    ds_read_b64_tr_b16 v[18:19], v0 offset:13056
    s_waitcnt lgkmcnt(6)
    v_mfma_f32_16x16x32_bf16 v[112:115], v[24:27], v[184:187], v[112:115]
    ds_read_b64_tr_b16 v[20:21], v1 offset:12288
    v_mfma_f32_16x16x32_bf16 v[120:123], v[24:27], v[188:191], v[120:123]
    ds_read_b64_tr_b16 v[22:23], v1 offset:13056
    v_mfma_f32_16x16x32_bf16 v[116:119], v[28:31], v[184:187], v[116:119]
    ds_read_b64_tr_b16 v[24:25], v0 offset:64
    v_mfma_f32_16x16x32_bf16 v[124:127], v[28:31], v[188:191], v[124:127]
    ds_read_b64_tr_b16 v[26:27], v0 offset:832
    s_waitcnt lgkmcnt(6)
    v_mfma_f32_16x16x32_bf16 v[32:35], v[8:11], v[192:195], v[32:35]
    ds_read_b64_tr_b16 v[28:29], v1 offset:64
    v_mfma_f32_16x16x32_bf16 v[40:43], v[8:11], v[196:199], v[40:43]
    ds_read_b64_tr_b16 v[30:31], v1 offset:832
    v_mfma_f32_16x16x32_bf16 v[36:39], v[12:15], v[192:195], v[36:39]
    ds_read_b64_tr_b16 v[8:9], v0 offset:12352
    s_mov_b64 exec, 1
    buffer_load_dword off, s[28:31], 20 lds
    s_mov_b64 exec, -1
    v_mfma_f32_16x16x32_bf16 v[44:47], v[12:15], v[196:199], v[44:47]
    ds_read_b64_tr_b16 v[10:11], v0 offset:13120
    s_waitcnt lgkmcnt(6)
    v_mfma_f32_16x16x32_bf16 v[48:51], v[16:19], v[192:195], v[48:51]
    ds_read_b64_tr_b16 v[12:13], v1 offset:12352
    v_mfma_f32_16x16x32_bf16 v[56:59], v[16:19], v[196:199], v[56:59]
    ds_read_b64_tr_b16 v[14:15], v1 offset:13120
    v_mfma_f32_16x16x32_bf16 v[52:55], v[20:23], v[192:195], v[52:55]
    ds_read_b64_tr_b16 v[16:17], v0 offset:128
    v_mfma_f32_16x16x32_bf16 v[60:63], v[20:23], v[196:199], v[60:63]
    ds_read_b64_tr_b16 v[18:19], v0 offset:896
    s_waitcnt lgkmcnt(6)
    v_mfma_f32_16x16x32_bf16 v[64:67], v[24:27], v[192:195], v[64:67]
    ds_read_b64_tr_b16 v[20:21], v1 offset:128
    v_mfma_f32_16x16x32_bf16 v[72:75], v[24:27], v[196:199], v[72:75]
    ds_read_b64_tr_b16 v[22:23], v1 offset:896
    v_mfma_f32_16x16x32_bf16 v[68:71], v[28:31], v[192:195], v[68:71]
    ds_read_b64_tr_b16 v[24:25], v0 offset:12416
    v_mfma_f32_16x16x32_bf16 v[76:79], v[28:31], v[196:199], v[76:79]
    ds_read_b64_tr_b16 v[26:27], v0 offset:13184
    s_waitcnt lgkmcnt(6)
    v_mfma_f32_16x16x32_bf16 v[80:83], v[8:11], v[192:195], v[80:83]
    ds_read_b64_tr_b16 v[28:29], v1 offset:12416
    v_mfma_f32_16x16x32_bf16 v[88:91], v[8:11], v[196:199], v[88:91]
    ds_read_b64_tr_b16 v[30:31], v1 offset:13184
    v_mfma_f32_16x16x32_bf16 v[84:87], v[12:15], v[192:195], v[84:87]
    ds_read_b64_tr_b16 v[8:9], v0 offset:6144
    v_mfma_f32_16x16x32_bf16 v[92:95], v[12:15], v[196:199], v[92:95]
    ds_read_b64_tr_b16 v[10:11], v0 offset:6912
    s_waitcnt lgkmcnt(6)
    v_mfma_f32_16x16x32_bf16 v[96:99], v[16:19], v[192:195], v[96:99]
    ds_read_b64_tr_b16 v[12:13], v1 offset:6144
    v_mfma_f32_16x16x32_bf16 v[104:107], v[16:19], v[196:199], v[104:107]
    ds_read_b64_tr_b16 v[14:15], v1 offset:6912
    v_mfma_f32_16x16x32_bf16 v[100:103], v[20:23], v[192:195], v[100:103]
    ds_read_b64_tr_b16 v[16:17], v0 offset:18432
    v_mfma_f32_16x16x32_bf16 v[108:111], v[20:23], v[196:199], v[108:111]
    ds_read_b64_tr_b16 v[18:19], v0 offset:19200
    s_waitcnt lgkmcnt(6)
    v_mfma_f32_16x16x32_bf16 v[112:115], v[24:27], v[192:195], v[112:115]
    ds_read_b64_tr_b16 v[20:21], v1 offset:18432
    v_mfma_f32_16x16x32_bf16 v[120:123], v[24:27], v[196:199], v[120:123]
    ds_read_b64_tr_b16 v[22:23], v1 offset:19200
    v_mfma_f32_16x16x32_bf16 v[116:119], v[28:31], v[192:195], v[116:119]
    ds_read_b64_tr_b16 v[24:25], v0 offset:6208
    ds_read_b32 v6, v5 offset:16
    v_mfma_f32_16x16x32_bf16 v[124:127], v[28:31], v[196:199], v[124:127]
    ds_read_b64_tr_b16 v[26:27], v0 offset:6976
    s_waitcnt lgkmcnt(7)
    v_mfma_f32_16x16x32_bf16 v[32:35], v[8:11], v[200:203], v[32:35]
    ds_read_b64_tr_b16 v[28:29], v1 offset:6208
    v_mfma_f32_16x16x32_bf16 v[40:43], v[8:11], v[204:207], v[40:43]
    ds_read_b64_tr_b16 v[30:31], v1 offset:6976
    v_mfma_f32_16x16x32_bf16 v[36:39], v[12:15], v[200:203], v[36:39]
    ds_read_b64_tr_b16 v[8:9], v0 offset:18496
    v_mfma_f32_16x16x32_bf16 v[44:47], v[12:15], v[204:207], v[44:47]
    ds_read_b64_tr_b16 v[10:11], v0 offset:19264
    s_waitcnt lgkmcnt(7)
    v_mfma_f32_16x16x32_bf16 v[48:51], v[16:19], v[200:203], v[48:51]
    ds_read_b64_tr_b16 v[12:13], v1 offset:18496
    v_mfma_f32_16x16x32_bf16 v[56:59], v[16:19], v[204:207], v[56:59]
    ds_read_b64_tr_b16 v[14:15], v1 offset:19264
    v_mfma_f32_16x16x32_bf16 v[52:55], v[20:23], v[200:203], v[52:55]
    ds_read_b64_tr_b16 v[16:17], v0 offset:6272
    v_mfma_f32_16x16x32_bf16 v[60:63], v[20:23], v[204:207], v[60:63]
    ds_read_b64_tr_b16 v[18:19], v0 offset:7040
    s_waitcnt lgkmcnt(6)
    v_mfma_f32_16x16x32_bf16 v[64:67], v[24:27], v[200:203], v[64:67]
    ds_read_b64_tr_b16 v[20:21], v1 offset:6272
    v_mfma_f32_16x16x32_bf16 v[72:75], v[24:27], v[204:207], v[72:75]
    ds_read_b64_tr_b16 v[22:23], v1 offset:7040
    v_mfma_f32_16x16x32_bf16 v[68:71], v[28:31], v[200:203], v[68:71]
    ds_read_b64_tr_b16 v[24:25], v0 offset:18560
    v_mfma_f32_16x16x32_bf16 v[76:79], v[28:31], v[204:207], v[76:79]
    ds_read_b64_tr_b16 v[26:27], v0 offset:19328
    s_waitcnt lgkmcnt(6)
    v_mfma_f32_16x16x32_bf16 v[80:83], v[8:11], v[200:203], v[80:83]
    ds_read_b64_tr_b16 v[28:29], v1 offset:18560
    v_cmp_gt_u32 vcc, 5, v6
    v_mfma_f32_16x16x32_bf16 v[88:91], v[8:11], v[204:207], v[88:91]
    ds_read_b64_tr_b16 v[30:31], v1 offset:19328
    v_mfma_f32_16x16x32_bf16 v[84:87], v[12:15], v[200:203], v[84:87]
    s_cbranch_vccnz L_slow5
L_back5:
    ds_read_b64_tr_b16 v[8:9], v0 offset:24576
    v_mfma_f32_16x16x32_bf16 v[92:95], v[12:15], v[204:207], v[92:95]
    ds_read_b64_tr_b16 v[10:11], v0 offset:25344
    s_waitcnt lgkmcnt(6)
    v_mfma_f32_16x16x32_bf16 v[96:99], v[16:19], v[200:203], v[96:99]
    ds_read_b64_tr_b16 v[12:13], v1 offset:24576
    v_mfma_f32_16x16x32_bf16 v[104:107], v[16:19], v[204:207], v[104:107]
    ds_read_b64_tr_b16 v[14:15], v1 offset:25344
    v_mfma_f32_16x16x32_bf16 v[100:103], v[20:23], v[200:203], v[100:103]
    ds_read_b64_tr_b16 v[16:17], v0 offset:36864
    v_mfma_f32_16x16x32_bf16 v[108:111], v[20:23], v[204:207], v[108:111]
    ds_read_b64_tr_b16 v[18:19], v0 offset:37632
    s_waitcnt lgkmcnt(6)
    v_mfma_f32_16x16x32_bf16 v[112:115], v[24:27], v[200:203], v[112:115]
    ds_read_b64_tr_b16 v[20:21], v1 offset:36864
    v_mfma_f32_16x16x32_bf16 v[120:123], v[24:27], v[204:207], v[120:123]
    ds_read_b64_tr_b16 v[22:23], v1 offset:37632
    v_mfma_f32_16x16x32_bf16 v[116:119], v[28:31], v[200:203], v[116:119]
    ds_read_b64_tr_b16 v[24:25], v0 offset:24640
    v_mfma_f32_16x16x32_bf16 v[124:127], v[28:31], v[204:207], v[124:127]
    ds_read_b64_tr_b16 v[26:27], v0 offset:25408
    s_waitcnt lgkmcnt(6)
    v_mfma_f32_16x16x32_bf16 v[32:35], v[8:11], v[208:211], v[32:35]
    ds_read_b64_tr_b16 v[28:29], v1 offset:24640
    v_mfma_f32_16x16x32_bf16 v[40:43], v[8:11], v[212:215], v[40:43]
    ds_read_b64_tr_b16 v[30:31], v1 offset:25408
    v_mfma_f32_16x16x32_bf16 v[36:39], v[12:15], v[208:211], v[36:39]
    ds_read_b64_tr_b16 v[8:9], v0 offset:36928
    s_mov_b64 exec, 1
    buffer_load_dword off, s[28:31], 24 lds
    s_mov_b64 exec, -1
    v_mfma_f32_16x16x32_bf16 v[44:47], v[12:15], v[212:215], v[44:47]
    ds_read_b64_tr_b16 v[10:11], v0 offset:37696
    s_waitcnt lgkmcnt(6)
    v_mfma_f32_16x16x32_bf16 v[48:51], v[16:19], v[208:211], v[48:51]
    ds_read_b64_tr_b16 v[12:13], v1 offset:36928
    v_mfma_f32_16x16x32_bf16 v[56:59], v[16:19], v[212:215], v[56:59]
    ds_read_b64_tr_b16 v[14:15], v1 offset:37696
    v_mfma_f32_16x16x32_bf16 v[52:55], v[20:23], v[208:211], v[52:55]
    ds_read_b64_tr_b16 v[16:17], v0 offset:24704
    v_mfma_f32_16x16x32_bf16 v[60:63], v[20:23], v[212:215], v[60:63]
    ds_read_b64_tr_b16 v[18:19], v0 offset:25472
    s_waitcnt lgkmcnt(6)
    v_mfma_f32_16x16x32_bf16 v[64:67], v[24:27], v[208:211], v[64:67]
    ds_read_b64_tr_b16 v[20:21], v1 offset:24704
    v_mfma_f32_16x16x32_bf16 v[72:75], v[24:27], v[212:215], v[72:75]
    ds_read_b64_tr_b16 v[22:23], v1 offset:25472
    v_mfma_f32_16x16x32_bf16 v[68:71], v[28:31], v[208:211], v[68:71]
    ds_read_b64_tr_b16 v[24:25], v0 offset:36992
    v_mfma_f32_16x16x32_bf16 v[76:79], v[28:31], v[212:215], v[76:79]
    ds_read_b64_tr_b16 v[26:27], v0 offset:37760
    s_waitcnt lgkmcnt(6)
    v_mfma_f32_16x16x32_bf16 v[80:83], v[8:11], v[208:211], v[80:83]
    ds_read_b64_tr_b16 v[28:29], v1 offset:36992
    v_mfma_f32_16x16x32_bf16 v[88:91], v[8:11], v[212:215], v[88:91]
    ds_read_b64_tr_b16 v[30:31], v1 offset:37760
    v_mfma_f32_16x16x32_bf16 v[84:87], v[12:15], v[208:211], v[84:87]
    ds_read_b64_tr_b16 v[8:9], v0 offset:30720
    v_mfma_f32_16x16x32_bf16 v[92:95], v[12:15], v[212:215], v[92:95]
    ds_read_b64_tr_b16 v[10:11], v0 offset:31488
    s_waitcnt lgkmcnt(6)
    v_mfma_f32_16x16x32_bf16 v[96:99], v[16:19], v[208:211], v[96:99]
    ds_read_b64_tr_b16 v[12:13], v1 offset:30720
    v_mfma_f32_16x16x32_bf16 v[104:107], v[16:19], v[212:215], v[104:107]
    ds_read_b64_tr_b16 v[14:15], v1 offset:31488
    v_mfma_f32_16x16x32_bf16 v[100:103], v[20:23], v[208:211], v[100:103]
    ds_read_b64_tr_b16 v[16:17], v0 offset:43008
    v_mfma_f32_16x16x32_bf16 v[108:111], v[20:23], v[212:215], v[108:111]
    ds_read_b64_tr_b16 v[18:19], v0 offset:43776
    s_waitcnt lgkmcnt(6)
    v_mfma_f32_16x16x32_bf16 v[112:115], v[24:27], v[208:211], v[112:115]
    ds_read_b64_tr_b16 v[20:21], v1 offset:43008
    v_mfma_f32_16x16x32_bf16 v[120:123], v[24:27], v[212:215], v[120:123]
    ds_read_b64_tr_b16 v[22:23], v1 offset:43776
    v_mfma_f32_16x16x32_bf16 v[116:119], v[28:31], v[208:211], v[116:119]
    ds_read_b64_tr_b16 v[24:25], v0 offset:30784
    ds_read_b32 v6, v5 offset:16
    v_mfma_f32_16x16x32_bf16 v[124:127], v[28:31], v[212:215], v[124:127]
    ds_read_b64_tr_b16 v[26:27], v0 offset:31552
    s_waitcnt lgkmcnt(7)
    v_mfma_f32_16x16x32_bf16 v[32:35], v[8:11], v[216:219], v[32:35]
    ds_read_b64_tr_b16 v[28:29], v1 offset:30784
    v_mfma_f32_16x16x32_bf16 v[40:43], v[8:11], v[220:223], v[40:43]
    ds_read_b64_tr_b16 v[30:31], v1 offset:31552
    v_mfma_f32_16x16x32_bf16 v[36:39], v[12:15], v[216:219], v[36:39]
    ds_read_b64_tr_b16 v[8:9], v0 offset:43072
    v_mfma_f32_16x16x32_bf16 v[44:47], v[12:15], v[220:223], v[44:47]
    ds_read_b64_tr_b16 v[10:11], v0 offset:43840
    s_waitcnt lgkmcnt(7)
    v_mfma_f32_16x16x32_bf16 v[48:51], v[16:19], v[216:219], v[48:51]
    ds_read_b64_tr_b16 v[12:13], v1 offset:43072
    v_mfma_f32_16x16x32_bf16 v[56:59], v[16:19], v[220:223], v[56:59]
    ds_read_b64_tr_b16 v[14:15], v1 offset:43840
    v_mfma_f32_16x16x32_bf16 v[52:55], v[20:23], v[216:219], v[52:55]
    ds_read_b64_tr_b16 v[16:17], v0 offset:30848
    v_mfma_f32_16x16x32_bf16 v[60:63], v[20:23], v[220:223], v[60:63]
    ds_read_b64_tr_b16 v[18:19], v0 offset:31616
    s_waitcnt lgkmcnt(6)
    v_mfma_f32_16x16x32_bf16 v[64:67], v[24:27], v[216:219], v[64:67]
    ds_read_b64_tr_b16 v[20:21], v1 offset:30848
    v_mfma_f32_16x16x32_bf16 v[72:75], v[24:27], v[220:223], v[72:75]
    ds_read_b64_tr_b16 v[22:23], v1 offset:31616
    v_mfma_f32_16x16x32_bf16 v[68:71], v[28:31], v[216:219], v[68:71]
    ds_read_b64_tr_b16 v[24:25], v0 offset:43136
    v_mfma_f32_16x16x32_bf16 v[76:79], v[28:31], v[220:223], v[76:79]
    ds_read_b64_tr_b16 v[26:27], v0 offset:43904
    s_waitcnt lgkmcnt(6)
    v_mfma_f32_16x16x32_bf16 v[80:83], v[8:11], v[216:219], v[80:83]
    ds_read_b64_tr_b16 v[28:29], v1 offset:43136
    v_cmp_gt_u32 vcc, 6, v6
    v_mfma_f32_16x16x32_bf16 v[88:91], v[8:11], v[220:223], v[88:91]
    ds_read_b64_tr_b16 v[30:31], v1 offset:43904
    v_mfma_f32_16x16x32_bf16 v[84:87], v[12:15], v[216:219], v[84:87]
    s_cbranch_vccnz L_slow6
L_back6:
    ds_read_b64_tr_b16 v[8:9], v2 offset:0
    v_mfma_f32_16x16x32_bf16 v[92:95], v[12:15], v[220:223], v[92:95]
    ds_read_b64_tr_b16 v[10:11], v2 offset:768
    s_waitcnt lgkmcnt(6)
    v_mfma_f32_16x16x32_bf16 v[96:99], v[16:19], v[216:219], v[96:99]
    ds_read_b64_tr_b16 v[12:13], v3 offset:0
    v_mfma_f32_16x16x32_bf16 v[104:107], v[16:19], v[220:223], v[104:107]
    ds_read_b64_tr_b16 v[14:15], v3 offset:768
    v_mfma_f32_16x16x32_bf16 v[100:103], v[20:23], v[216:219], v[100:103]
    ds_read_b64_tr_b16 v[16:17], v2 offset:12288
    v_mfma_f32_16x16x32_bf16 v[108:111], v[20:23], v[220:223], v[108:111]
    ds_read_b64_tr_b16 v[18:19], v2 offset:13056
    s_waitcnt lgkmcnt(6)
    v_mfma_f32_16x16x32_bf16 v[112:115], v[24:27], v[216:219], v[112:115]
    ds_read_b64_tr_b16 v[20:21], v3 offset:12288
    v_mfma_f32_16x16x32_bf16 v[120:123], v[24:27], v[220:223], v[120:123]
    ds_read_b64_tr_b16 v[22:23], v3 offset:13056
    v_mfma_f32_16x16x32_bf16 v[116:119], v[28:31], v[216:219], v[116:119]
    ds_read_b64_tr_b16 v[24:25], v2 offset:64
    v_mfma_f32_16x16x32_bf16 v[124:127], v[28:31], v[220:223], v[124:127]
    ds_read_b64_tr_b16 v[26:27], v2 offset:832
    s_waitcnt lgkmcnt(6)
    v_mfma_f32_16x16x32_bf16 v[32:35], v[8:11], v[224:227], v[32:35]
    ds_read_b64_tr_b16 v[28:29], v3 offset:64
    v_mfma_f32_16x16x32_bf16 v[40:43], v[8:11], v[228:231], v[40:43]
    ds_read_b64_tr_b16 v[30:31], v3 offset:832
    v_mfma_f32_16x16x32_bf16 v[36:39], v[12:15], v[224:227], v[36:39]
    ds_read_b64_tr_b16 v[8:9], v2 offset:12352
    s_mov_b64 exec, 1
    buffer_load_dword off, s[28:31], 28 lds
    s_mov_b64 exec, -1
    v_mfma_f32_16x16x32_bf16 v[44:47], v[12:15], v[228:231], v[44:47]
    ds_read_b64_tr_b16 v[10:11], v2 offset:13120
    s_waitcnt lgkmcnt(6)
    v_mfma_f32_16x16x32_bf16 v[48:51], v[16:19], v[224:227], v[48:51]
    ds_read_b64_tr_b16 v[12:13], v3 offset:12352
    v_mfma_f32_16x16x32_bf16 v[56:59], v[16:19], v[228:231], v[56:59]
    ds_read_b64_tr_b16 v[14:15], v3 offset:13120
    v_mfma_f32_16x16x32_bf16 v[52:55], v[20:23], v[224:227], v[52:55]
    ds_read_b64_tr_b16 v[16:17], v2 offset:128
    v_mfma_f32_16x16x32_bf16 v[60:63], v[20:23], v[228:231], v[60:63]
    ds_read_b64_tr_b16 v[18:19], v2 offset:896
    s_waitcnt lgkmcnt(6)
    v_mfma_f32_16x16x32_bf16 v[64:67], v[24:27], v[224:227], v[64:67]
    ds_read_b64_tr_b16 v[20:21], v3 offset:128
    v_mfma_f32_16x16x32_bf16 v[72:75], v[24:27], v[228:231], v[72:75]
    ds_read_b64_tr_b16 v[22:23], v3 offset:896
    v_mfma_f32_16x16x32_bf16 v[68:71], v[28:31], v[224:227], v[68:71]
    ds_read_b64_tr_b16 v[24:25], v2 offset:12416
    v_mfma_f32_16x16x32_bf16 v[76:79], v[28:31], v[228:231], v[76:79]
    ds_read_b64_tr_b16 v[26:27], v2 offset:13184
    s_waitcnt lgkmcnt(6)
    v_mfma_f32_16x16x32_bf16 v[80:83], v[8:11], v[224:227], v[80:83]
    ds_read_b64_tr_b16 v[28:29], v3 offset:12416
    v_mfma_f32_16x16x32_bf16 v[88:91], v[8:11], v[228:231], v[88:91]
    ds_read_b64_tr_b16 v[30:31], v3 offset:13184
    v_mfma_f32_16x16x32_bf16 v[84:87], v[12:15], v[224:227], v[84:87]
    ds_read_b64_tr_b16 v[8:9], v2 offset:6144
    v_mfma_f32_16x16x32_bf16 v[92:95], v[12:15], v[228:231], v[92:95]
    ds_read_b64_tr_b16 v[10:11], v2 offset:6912
    s_waitcnt lgkmcnt(6)
    v_mfma_f32_16x16x32_bf16 v[96:99], v[16:19], v[224:227], v[96:99]
    ds_read_b64_tr_b16 v[12:13], v3 offset:6144
    v_mfma_f32_16x16x32_bf16 v[104:107], v[16:19], v[228:231], v[104:107]
    ds_read_b64_tr_b16 v[14:15], v3 offset:6912
    v_mfma_f32_16x16x32_bf16 v[100:103], v[20:23], v[224:227], v[100:103]
    ds_read_b64_tr_b16 v[16:17], v2 offset:18432
    v_mfma_f32_16x16x32_bf16 v[108:111], v[20:23], v[228:231], v[108:111]
    ds_read_b64_tr_b16 v[18:19], v2 offset:19200
    s_waitcnt lgkmcnt(6)
    v_mfma_f32_16x16x32_bf16 v[112:115], v[24:27], v[224:227], v[112:115]
    ds_read_b64_tr_b16 v[20:21], v3 offset:18432
    v_mfma_f32_16x16x32_bf16 v[120:123], v[24:27], v[228:231], v[120:123]
    ds_read_b64_tr_b16 v[22:23], v3 offset:19200
    v_mfma_f32_16x16x32_bf16 v[116:119], v[28:31], v[224:227], v[116:119]
    ds_read_b64_tr_b16 v[24:25], v2 offset:6208
    ds_read_b32 v6, v5 offset:16
    v_mfma_f32_16x16x32_bf16 v[124:127], v[28:31], v[228:231], v[124:127]
    ds_read_b64_tr_b16 v[26:27], v2 offset:6976
    s_waitcnt lgkmcnt(7)
    v_mfma_f32_16x16x32_bf16 v[32:35], v[8:11], v[232:235], v[32:35]
    ds_read_b64_tr_b16 v[28:29], v3 offset:6208
    v_mfma_f32_16x16x32_bf16 v[40:43], v[8:11], v[236:239], v[40:43]
    ds_read_b64_tr_b16 v[30:31], v3 offset:6976
    v_mfma_f32_16x16x32_bf16 v[36:39], v[12:15], v[232:235], v[36:39]
    ds_read_b64_tr_b16 v[8:9], v2 offset:18496
    v_mfma_f32_16x16x32_bf16 v[44:47], v[12:15], v[236:239], v[44:47]
    ds_read_b64_tr_b16 v[10:11], v2 offset:19264
    s_waitcnt lgkmcnt(7)
    v_mfma_f32_16x16x32_bf16 v[48:51], v[16:19], v[232:235], v[48:51]
    ds_read_b64_tr_b16 v[12:13], v3 offset:18496
    v_mfma_f32_16x16x32_bf16 v[56:59], v[16:19], v[236:239], v[56:59]
    ds_read_b64_tr_b16 v[14:15], v3 offset:19264
    v_mfma_f32_16x16x32_bf16 v[52:55], v[20:23], v[232:235], v[52:55]
    ds_read_b64_tr_b16 v[16:17], v2 offset:6272
    v_mfma_f32_16x16x32_bf16 v[60:63], v[20:23], v[236:239], v[60:63]
    ds_read_b64_tr_b16 v[18:19], v2 offset:7040
    s_waitcnt lgkmcnt(6)
    v_mfma_f32_16x16x32_bf16 v[64:67], v[24:27], v[232:235], v[64:67]
    ds_read_b64_tr_b16 v[20:21], v3 offset:6272
    v_mfma_f32_16x16x32_bf16 v[72:75], v[24:27], v[236:239], v[72:75]
    ds_read_b64_tr_b16 v[22:23], v3 offset:7040
    v_mfma_f32_16x16x32_bf16 v[68:71], v[28:31], v[232:235], v[68:71]
    ds_read_b64_tr_b16 v[24:25], v2 offset:18560
    v_mfma_f32_16x16x32_bf16 v[76:79], v[28:31], v[236:239], v[76:79]
    ds_read_b64_tr_b16 v[26:27], v2 offset:19328
    s_waitcnt lgkmcnt(6)
    v_mfma_f32_16x16x32_bf16 v[80:83], v[8:11], v[232:235], v[80:83]
    ds_read_b64_tr_b16 v[28:29], v3 offset:18560
    v_cmp_gt_u32 vcc, 7, v6
    v_mfma_f32_16x16x32_bf16 v[88:91], v[8:11], v[236:239], v[88:91]
    ds_read_b64_tr_b16 v[30:31], v3 offset:19328
    v_mfma_f32_16x16x32_bf16 v[84:87], v[12:15], v[232:235], v[84:87]
    s_cbranch_vccnz L_slow7
L_back7:
    ds_read_b64_tr_b16 v[8:9], v2 offset:24576
    v_mfma_f32_16x16x32_bf16 v[92:95], v[12:15], v[236:239], v[92:95]
    ds_read_b64_tr_b16 v[10:11], v2 offset:25344
    s_waitcnt lgkmcnt(6)
    v_mfma_f32_16x16x32_bf16 v[96:99], v[16:19], v[232:235], v[96:99]
    ds_read_b64_tr_b16 v[12:13], v3 offset:24576
    v_mfma_f32_16x16x32_bf16 v[104:107], v[16:19], v[236:239], v[104:107]
    ds_read_b64_tr_b16 v[14:15], v3 offset:25344
    v_mfma_f32_16x16x32_bf16 v[100:103], v[20:23], v[232:235], v[100:103]
    ds_read_b64_tr_b16 v[16:17], v2 offset:36864
    v_mfma_f32_16x16x32_bf16 v[108:111], v[20:23], v[236:239], v[108:111]
    ds_read_b64_tr_b16 v[18:19], v2 offset:37632
    s_waitcnt lgkmcnt(6)
    v_mfma_f32_16x16x32_bf16 v[112:115], v[24:27], v[232:235], v[112:115]
    ds_read_b64_tr_b16 v[20:21], v3 offset:36864
    v_mfma_f32_16x16x32_bf16 v[120:123], v[24:27], v[236:239], v[120:123]
    ds_read_b64_tr_b16 v[22:23], v3 offset:37632
    v_mfma_f32_16x16x32_bf16 v[116:119], v[28:31], v[232:235], v[116:119]
    ds_read_b64_tr_b16 v[24:25], v2 offset:24640
    v_mfma_f32_16x16x32_bf16 v[124:127], v[28:31], v[236:239], v[124:127]
    ds_read_b64_tr_b16 v[26:27], v2 offset:25408
    s_waitcnt lgkmcnt(6)
    v_mfma_f32_16x16x32_bf16 v[32:35], v[8:11], v[240:243], v[32:35]
    ds_read_b64_tr_b16 v[28:29], v3 offset:24640
    v_mfma_f32_16x16x32_bf16 v[40:43], v[8:11], v[244:247], v[40:43]
    ds_read_b64_tr_b16 v[30:31], v3 offset:25408
    v_mfma_f32_16x16x32_bf16 v[36:39], v[12:15], v[240:243], v[36:39]
    ds_read_b64_tr_b16 v[8:9], v2 offset:36928
    s_mov_b64 exec, 1
    buffer_load_dword off, s[28:31], 32 lds
    s_mov_b64 exec, -1
    v_mfma_f32_16x16x32_bf16 v[44:47], v[12:15], v[244:247], v[44:47]
    ds_read_b64_tr_b16 v[10:11], v2 offset:37696
    s_waitcnt lgkmcnt(6)
    v_mfma_f32_16x16x32_bf16 v[48:51], v[16:19], v[240:243], v[48:51]
    ds_read_b64_tr_b16 v[12:13], v3 offset:36928
    v_mfma_f32_16x16x32_bf16 v[56:59], v[16:19], v[244:247], v[56:59]
    ds_read_b64_tr_b16 v[14:15], v3 offset:37696
    v_mfma_f32_16x16x32_bf16 v[52:55], v[20:23], v[240:243], v[52:55]
    ds_read_b64_tr_b16 v[16:17], v2 offset:24704
    v_mfma_f32_16x16x32_bf16 v[60:63], v[20:23], v[244:247], v[60:63]
    ds_read_b64_tr_b16 v[18:19], v2 offset:25472
    s_waitcnt lgkmcnt(6)
    v_mfma_f32_16x16x32_bf16 v[64:67], v[24:27], v[240:243], v[64:67]
    ds_read_b64_tr_b16 v[20:21], v3 offset:24704
    v_mfma_f32_16x16x32_bf16 v[72:75], v[24:27], v[244:247], v[72:75]
    ds_read_b64_tr_b16 v[22:23], v3 offset:25472
    v_mfma_f32_16x16x32_bf16 v[68:71], v[28:31], v[240:243], v[68:71]
    ds_read_b64_tr_b16 v[24:25], v2 offset:36992
    v_mfma_f32_16x16x32_bf16 v[76:79], v[28:31], v[244:247], v[76:79]
    ds_read_b64_tr_b16 v[26:27], v2 offset:37760
    s_waitcnt lgkmcnt(6)
    v_mfma_f32_16x16x32_bf16 v[80:83], v[8:11], v[240:243], v[80:83]
    ds_read_b64_tr_b16 v[28:29], v3 offset:36992
    v_mfma_f32_16x16x32_bf16 v[88:91], v[8:11], v[244:247], v[88:91]
    ds_read_b64_tr_b16 v[30:31], v3 offset:37760
    v_mfma_f32_16x16x32_bf16 v[84:87], v[12:15], v[240:243], v[84:87]
    ds_read_b64_tr_b16 v[8:9], v2 offset:30720
    v_mfma_f32_16x16x32_bf16 v[92:95], v[12:15], v[244:247], v[92:95]
    ds_read_b64_tr_b16 v[10:11], v2 offset:31488
    s_waitcnt lgkmcnt(6)
    v_mfma_f32_16x16x32_bf16 v[96:99], v[16:19], v[240:243], v[96:99]
    ds_read_b64_tr_b16 v[12:13], v3 offset:30720
    v_mfma_f32_16x16x32_bf16 v[104:107], v[16:19], v[244:247], v[104:107]
    ds_read_b64_tr_b16 v[14:15], v3 offset:31488
    v_mfma_f32_16x16x32_bf16 v[100:103], v[20:23], v[240:243], v[100:103]
    ds_read_b64_tr_b16 v[16:17], v2 offset:43008
    v_mfma_f32_16x16x32_bf16 v[108:111], v[20:23], v[244:247], v[108:111]
    ds_read_b64_tr_b16 v[18:19], v2 offset:43776
    s_waitcnt lgkmcnt(6)
    v_mfma_f32_16x16x32_bf16 v[112:115], v[24:27], v[240:243], v[112:115]
    ds_read_b64_tr_b16 v[20:21], v3 offset:43008
    v_mfma_f32_16x16x32_bf16 v[120:123], v[24:27], v[244:247], v[120:123]
    ds_read_b64_tr_b16 v[22:23], v3 offset:43776
    v_mfma_f32_16x16x32_bf16 v[116:119], v[28:31], v[240:243], v[116:119]
    ds_read_b64_tr_b16 v[24:25], v2 offset:30784
    v_mfma_f32_16x16x32_bf16 v[124:127], v[28:31], v[244:247], v[124:127]
    ds_read_b64_tr_b16 v[26:27], v2 offset:31552
    s_waitcnt lgkmcnt(6)
    v_mfma_f32_16x16x32_bf16 v[32:35], v[8:11], v[248:251], v[32:35]
    ds_read_b64_tr_b16 v[28:29], v3 offset:30784
    v_mfma_f32_16x16x32_bf16 v[40:43], v[8:11], v[252:255], v[40:43]
    ds_read_b64_tr_b16 v[30:31], v3 offset:31552
    v_mfma_f32_16x16x32_bf16 v[36:39], v[12:15], v[248:251], v[36:39]
    ds_read_b64_tr_b16 v[8:9], v2 offset:43072
    v_mfma_f32_16x16x32_bf16 v[44:47], v[12:15], v[252:255], v[44:47]
    ds_read_b64_tr_b16 v[10:11], v2 offset:43840
    s_waitcnt lgkmcnt(6)
    v_mfma_f32_16x16x32_bf16 v[48:51], v[16:19], v[248:251], v[48:51]
    ds_read_b64_tr_b16 v[12:13], v3 offset:43072
    v_mfma_f32_16x16x32_bf16 v[56:59], v[16:19], v[252:255], v[56:59]
    ds_read_b64_tr_b16 v[14:15], v3 offset:43840
    v_mfma_f32_16x16x32_bf16 v[52:55], v[20:23], v[248:251], v[52:55]
    ds_read_b64_tr_b16 v[16:17], v2 offset:30848
    v_mfma_f32_16x16x32_bf16 v[60:63], v[20:23], v[252:255], v[60:63]
    ds_read_b64_tr_b16 v[18:19], v2 offset:31616
    s_waitcnt lgkmcnt(6)
    v_mfma_f32_16x16x32_bf16 v[64:67], v[24:27], v[248:251], v[64:67]
    ds_read_b64_tr_b16 v[20:21], v3 offset:30848
    v_mfma_f32_16x16x32_bf16 v[72:75], v[24:27], v[252:255], v[72:75]
    ds_read_b64_tr_b16 v[22:23], v3 offset:31616
    v_mfma_f32_16x16x32_bf16 v[68:71], v[28:31], v[248:251], v[68:71]
    ds_read_b64_tr_b16 v[24:25], v2 offset:43136
    v_mfma_f32_16x16x32_bf16 v[76:79], v[28:31], v[252:255], v[76:79]
    ds_read_b64_tr_b16 v[26:27], v2 offset:43904
    s_waitcnt lgkmcnt(6)
    v_mfma_f32_16x16x32_bf16 v[80:83], v[8:11], v[248:251], v[80:83]
    ds_read_b64_tr_b16 v[28:29], v3 offset:43136
    v_mfma_f32_16x16x32_bf16 v[88:91], v[8:11], v[252:255], v[88:91]
    ds_read_b64_tr_b16 v[30:31], v3 offset:43904
    v_mfma_f32_16x16x32_bf16 v[84:87], v[12:15], v[248:251], v[84:87]
    v_mfma_f32_16x16x32_bf16 v[92:95], v[12:15], v[252:255], v[92:95]
    s_waitcnt lgkmcnt(4)
    v_mfma_f32_16x16x32_bf16 v[96:99], v[16:19], v[248:251], v[96:99]
    v_mfma_f32_16x16x32_bf16 v[104:107], v[16:19], v[252:255], v[104:107]
    v_mfma_f32_16x16x32_bf16 v[100:103], v[20:23], v[248:251], v[100:103]
    v_mfma_f32_16x16x32_bf16 v[108:111], v[20:23], v[252:255], v[108:111]
    s_waitcnt lgkmcnt(0)
    v_mfma_f32_16x16x32_bf16 v[112:115], v[24:27], v[248:251], v[112:115]
    v_mfma_f32_16x16x32_bf16 v[120:123], v[24:27], v[252:255], v[120:123]
    v_mfma_f32_16x16x32_bf16 v[116:119], v[28:31], v[248:251], v[116:119]
    v_mfma_f32_16x16x32_bf16 v[124:127], v[28:31], v[252:255], v[124:127]
    s_waitcnt vmcnt(0)
    v_mov_b32 v6, 9
    ds_write_b32 v4, v6 offset:0
    s_setprio 0
    v_mbcnt_lo_u32_b32 v0, -1, 0
    v_mbcnt_hi_u32_b32 v0, -1, v0
    v_and_b32 v1, 15, v0
    v_lshl_add_u32 v1, v1, 2, s22
    ds_read_b32 v2, v1
    ds_read_b32 v3, v1 offset:64
    v_and_b32 v6, 15, v0
    v_lshl_add_u32 v6, v6, 4, s34
    v_lshrrev_b32 v1, 4, v0
    v_lshl_add_u32 v1, v1, 9, v6
    s_mov_b32 s84, 3216550459
    s_mov_b32 s85, 3216550459
    v_pk_mul_f32 v[48:49], v[32:33], v[48:49]
    v_pk_mul_f32 v[50:51], v[34:35], v[50:51]
    v_pk_mul_f32 v[52:53], v[36:37], v[52:53]
    v_pk_mul_f32 v[54:55], v[38:39], v[54:55]
    v_pk_mul_f32 v[56:57], v[40:41], v[56:57]
    v_pk_mul_f32 v[58:59], v[42:43], v[58:59]
    v_pk_mul_f32 v[60:61], v[44:45], v[60:61]
    v_pk_mul_f32 v[62:63], v[46:47], v[62:63]
    v_pk_mul_f32 v[32:33], v[32:33], s[84:85]
    v_pk_mul_f32 v[34:35], v[34:35], s[84:85]
    v_pk_mul_f32 v[36:37], v[36:37], s[84:85]
    v_pk_mul_f32 v[38:39], v[38:39], s[84:85]
    v_pk_mul_f32 v[40:41], v[40:41], s[84:85]
    v_pk_mul_f32 v[42:43], v[42:43], s[84:85]
    v_pk_mul_f32 v[44:45], v[44:45], s[84:85]
    v_pk_mul_f32 v[46:47], v[46:47], s[84:85]
    s_waitcnt lgkmcnt(0)
    v_mul_f32 v2, 1069066811, v2
    v_mul_f32 v3, 1069066811, v3
    v_exp_f32 v2, v2
    v_exp_f32 v3, v3
    v_exp_f32 v32, v32
    v_exp_f32 v33, v33
    v_exp_f32 v34, v34
    v_exp_f32 v35, v35
    v_exp_f32 v36, v36
    v_exp_f32 v37, v37
    v_exp_f32 v38, v38
    v_exp_f32 v39, v39
    v_exp_f32 v40, v40
    v_exp_f32 v41, v41
    v_exp_f32 v42, v42
    v_exp_f32 v43, v43
    v_exp_f32 v44, v44
    v_exp_f32 v45, v45
    v_exp_f32 v46, v46
    v_exp_f32 v47, v47
    v_add_f32 v2, 1.0, v2
    v_add_f32 v3, 1.0, v3
    v_min_f32 v128, 0x7149f2ca, v2
    v_min_f32 v129, 0x7149f2ca, v2
    v_min_f32 v130, 0x7149f2ca, v3
    v_min_f32 v131, 0x7149f2ca, v3
    v_pk_fma_f32 v[32:33], v[32:33], v[128:129], v[128:129]
    v_pk_fma_f32 v[34:35], v[34:35], v[128:129], v[128:129]
    v_pk_fma_f32 v[36:37], v[36:37], v[128:129], v[128:129]
    v_pk_fma_f32 v[38:39], v[38:39], v[128:129], v[128:129]
    v_pk_fma_f32 v[40:41], v[40:41], v[130:131], v[130:131]
    v_pk_fma_f32 v[42:43], v[42:43], v[130:131], v[130:131]
    v_pk_fma_f32 v[44:45], v[44:45], v[130:131], v[130:131]
    v_pk_fma_f32 v[46:47], v[46:47], v[130:131], v[130:131]
    v_rcp_f32 v32, v32
    v_rcp_f32 v33, v33
    v_rcp_f32 v34, v34
    v_rcp_f32 v35, v35
    v_rcp_f32 v36, v36
    v_rcp_f32 v37, v37
    v_rcp_f32 v38, v38
    v_rcp_f32 v39, v39
    v_rcp_f32 v40, v40
    v_rcp_f32 v41, v41
    v_rcp_f32 v42, v42
    v_rcp_f32 v43, v43
    v_rcp_f32 v44, v44
    v_rcp_f32 v45, v45
    v_rcp_f32 v46, v46
    v_rcp_f32 v47, v47
    v_pk_mul_f32 v[48:49], v[32:33], v[48:49]
    v_pk_mul_f32 v[50:51], v[34:35], v[50:51]
    v_pk_mul_f32 v[52:53], v[36:37], v[52:53]
    v_pk_mul_f32 v[54:55], v[38:39], v[54:55]
    v_pk_mul_f32 v[56:57], v[40:41], v[56:57]
    v_pk_mul_f32 v[58:59], v[42:43], v[58:59]
    v_pk_mul_f32 v[60:61], v[44:45], v[60:61]
    v_pk_mul_f32 v[62:63], v[46:47], v[62:63]
    v_cvt_pk_bf16_f32 v8, v48, v49
    v_cvt_pk_bf16_f32 v9, v50, v51
    v_cvt_pk_bf16_f32 v10, v52, v53
    v_cvt_pk_bf16_f32 v11, v54, v55
    v_cvt_pk_bf16_f32 v12, v56, v57
    v_cvt_pk_bf16_f32 v13, v58, v59
    v_cvt_pk_bf16_f32 v14, v60, v61
    v_cvt_pk_bf16_f32 v15, v62, v63
    s_setprio 3
    buffer_store_dwordx4 v[8:11], v1, s[44:47], 0 offen offset:0 sc1
    buffer_store_dwordx4 v[12:15], v1, s[44:47], 0 offen offset:2048 sc1
    s_setprio 0
    v_pk_mul_f32 v[80:81], v[64:65], v[80:81]
    v_pk_mul_f32 v[82:83], v[66:67], v[82:83]
    v_pk_mul_f32 v[84:85], v[68:69], v[84:85]
    v_pk_mul_f32 v[86:87], v[70:71], v[86:87]
    v_pk_mul_f32 v[88:89], v[72:73], v[88:89]
    v_pk_mul_f32 v[90:91], v[74:75], v[90:91]
    v_pk_mul_f32 v[92:93], v[76:77], v[92:93]
    v_pk_mul_f32 v[94:95], v[78:79], v[94:95]
    v_pk_mul_f32 v[64:65], v[64:65], s[84:85]
    v_pk_mul_f32 v[66:67], v[66:67], s[84:85]
    v_pk_mul_f32 v[68:69], v[68:69], s[84:85]
    v_pk_mul_f32 v[70:71], v[70:71], s[84:85]
    v_pk_mul_f32 v[72:73], v[72:73], s[84:85]
    v_pk_mul_f32 v[74:75], v[74:75], s[84:85]
    v_pk_mul_f32 v[76:77], v[76:77], s[84:85]
    v_pk_mul_f32 v[78:79], v[78:79], s[84:85]
    v_exp_f32 v64, v64
    v_exp_f32 v65, v65
    v_exp_f32 v66, v66
    v_exp_f32 v67, v67
    v_exp_f32 v68, v68
    v_exp_f32 v69, v69
    v_exp_f32 v70, v70
    v_exp_f32 v71, v71
    v_exp_f32 v72, v72
    v_exp_f32 v73, v73
    v_exp_f32 v74, v74
    v_exp_f32 v75, v75
    v_exp_f32 v76, v76
    v_exp_f32 v77, v77
    v_exp_f32 v78, v78
    v_exp_f32 v79, v79
    v_pk_fma_f32 v[64:65], v[64:65], v[128:129], v[128:129]
    v_pk_fma_f32 v[66:67], v[66:67], v[128:129], v[128:129]
    v_pk_fma_f32 v[68:69], v[68:69], v[128:129], v[128:129]
    v_pk_fma_f32 v[70:71], v[70:71], v[128:129], v[128:129]
    v_pk_fma_f32 v[72:73], v[72:73], v[130:131], v[130:131]
    v_pk_fma_f32 v[74:75], v[74:75], v[130:131], v[130:131]
    v_pk_fma_f32 v[76:77], v[76:77], v[130:131], v[130:131]
    v_pk_fma_f32 v[78:79], v[78:79], v[130:131], v[130:131]
    v_rcp_f32 v64, v64
    v_rcp_f32 v65, v65
    v_rcp_f32 v66, v66
    v_rcp_f32 v67, v67
    v_rcp_f32 v68, v68
    v_rcp_f32 v69, v69
    v_rcp_f32 v70, v70
    v_rcp_f32 v71, v71
    v_rcp_f32 v72, v72
    v_rcp_f32 v73, v73
    v_rcp_f32 v74, v74
    v_rcp_f32 v75, v75
    v_rcp_f32 v76, v76
    v_rcp_f32 v77, v77
    v_rcp_f32 v78, v78
    v_rcp_f32 v79, v79
    v_pk_mul_f32 v[80:81], v[64:65], v[80:81]
    v_pk_mul_f32 v[82:83], v[66:67], v[82:83]
    v_pk_mul_f32 v[84:85], v[68:69], v[84:85]
    v_pk_mul_f32 v[86:87], v[70:71], v[86:87]
    v_pk_mul_f32 v[88:89], v[72:73], v[88:89]
    v_pk_mul_f32 v[90:91], v[74:75], v[90:91]
    v_pk_mul_f32 v[92:93], v[76:77], v[92:93]
    v_pk_mul_f32 v[94:95], v[78:79], v[94:95]
    v_cvt_pk_bf16_f32 v16, v80, v81
    v_cvt_pk_bf16_f32 v17, v82, v83
    v_cvt_pk_bf16_f32 v18, v84, v85
    v_cvt_pk_bf16_f32 v19, v86, v87
    v_cvt_pk_bf16_f32 v20, v88, v89
    v_cvt_pk_bf16_f32 v21, v90, v91
    v_cvt_pk_bf16_f32 v22, v92, v93
    v_cvt_pk_bf16_f32 v23, v94, v95
    s_setprio 3
    buffer_store_dwordx4 v[16:19], v1, s[44:47], s74 offen offset:0 sc1
    buffer_store_dwordx4 v[20:23], v1, s[44:47], s74 offen offset:2048 sc1
    s_setprio 0
    s_cmp_eq_u32 s41, 3
    s_cbranch_scc1 L_j3
    v_pk_mul_f32 v[112:113], v[96:97], v[112:113]
    v_pk_mul_f32 v[114:115], v[98:99], v[114:115]
    v_pk_mul_f32 v[116:117], v[100:101], v[116:117]
    v_pk_mul_f32 v[118:119], v[102:103], v[118:119]
    v_pk_mul_f32 v[120:121], v[104:105], v[120:121]
    v_pk_mul_f32 v[122:123], v[106:107], v[122:123]
    v_pk_mul_f32 v[124:125], v[108:109], v[124:125]
    v_pk_mul_f32 v[126:127], v[110:111], v[126:127]
    v_pk_mul_f32 v[96:97], v[96:97], s[84:85]
    v_pk_mul_f32 v[98:99], v[98:99], s[84:85]
    v_pk_mul_f32 v[100:101], v[100:101], s[84:85]
    v_pk_mul_f32 v[102:103], v[102:103], s[84:85]
    v_pk_mul_f32 v[104:105], v[104:105], s[84:85]
    v_pk_mul_f32 v[106:107], v[106:107], s[84:85]
    v_pk_mul_f32 v[108:109], v[108:109], s[84:85]
    v_pk_mul_f32 v[110:111], v[110:111], s[84:85]
    v_exp_f32 v96, v96
    v_exp_f32 v97, v97
    v_exp_f32 v98, v98
    v_exp_f32 v99, v99
    v_exp_f32 v100, v100
    v_exp_f32 v101, v101
    v_exp_f32 v102, v102
    v_exp_f32 v103, v103
    v_exp_f32 v104, v104
    v_exp_f32 v105, v105
    v_exp_f32 v106, v106
    v_exp_f32 v107, v107
    v_exp_f32 v108, v108
    v_exp_f32 v109, v109
    v_exp_f32 v110, v110
    v_exp_f32 v111, v111
    v_pk_fma_f32 v[96:97], v[96:97], v[128:129], v[128:129]
    v_pk_fma_f32 v[98:99], v[98:99], v[128:129], v[128:129]
    v_pk_fma_f32 v[100:101], v[100:101], v[128:129], v[128:129]
    v_pk_fma_f32 v[102:103], v[102:103], v[128:129], v[128:129]
    v_pk_fma_f32 v[104:105], v[104:105], v[130:131], v[130:131]
    v_pk_fma_f32 v[106:107], v[106:107], v[130:131], v[130:131]
    v_pk_fma_f32 v[108:109], v[108:109], v[130:131], v[130:131]
    v_pk_fma_f32 v[110:111], v[110:111], v[130:131], v[130:131]
    v_rcp_f32 v96, v96
    v_rcp_f32 v97, v97
    v_rcp_f32 v98, v98
    v_rcp_f32 v99, v99
    v_rcp_f32 v100, v100
    v_rcp_f32 v101, v101
    v_rcp_f32 v102, v102
    v_rcp_f32 v103, v103
    v_rcp_f32 v104, v104
    v_rcp_f32 v105, v105
    v_rcp_f32 v106, v106
    v_rcp_f32 v107, v107
    v_rcp_f32 v108, v108
    v_rcp_f32 v109, v109
    v_rcp_f32 v110, v110
    v_rcp_f32 v111, v111
    v_pk_mul_f32 v[112:113], v[96:97], v[112:113]
    v_pk_mul_f32 v[114:115], v[98:99], v[114:115]
    v_pk_mul_f32 v[116:117], v[100:101], v[116:117]
    v_pk_mul_f32 v[118:119], v[102:103], v[118:119]
    v_pk_mul_f32 v[120:121], v[104:105], v[120:121]
    v_pk_mul_f32 v[122:123], v[106:107], v[122:123]
    v_pk_mul_f32 v[124:125], v[108:109], v[124:125]
    v_pk_mul_f32 v[126:127], v[110:111], v[126:127]
    v_mov_b32 v6, 10
    ds_write_b32 v4, v6 offset:0
    v_cvt_pk_bf16_f32 v24, v112, v113
    v_cvt_pk_bf16_f32 v25, v114, v115
    v_cvt_pk_bf16_f32 v26, v116, v117
    v_cvt_pk_bf16_f32 v27, v118, v119
    v_cvt_pk_bf16_f32 v28, v120, v121
    v_cvt_pk_bf16_f32 v29, v122, v123
    v_cvt_pk_bf16_f32 v30, v124, v125
    v_cvt_pk_bf16_f32 v31, v126, v127
    s_setprio 3
    buffer_store_dwordx4 v[24:27], v1, s[44:47], s75 offen offset:0 sc1
    buffer_store_dwordx4 v[28:31], v1, s[44:47], s75 offen offset:2048 sc1
    s_setprio 0
L_no_u2:
    s_setprio 3
    v_lshrrev_b32 v72, 3, v0
    v_and_b32 v73, 6, v72
    v_and_b32 v40, 7, v0
    v_xor_b32 v73, v73, v40
    v_lshlrev_b32 v73, 4, v73
    v_lshl_add_u32 v72, v72, 10, v73
    s_mul_i32 s3, s40, 44
    s_add_u32 s3, s3, s42
    s_lshl_b32 s3, s3, 13
    s_lshr_b32 s81, s40, 1
    s_lshl1_add_u32 s81, s41, s81
    s_lshl_b32 s81, s81, 7
    s_add_u32 s3, s3, s81
    v_add_u32 v40, s3, v72
    v_xor_b32 v41, 0x80, v40
    s_lshl_b32 s22, s42, 11
L_pa9:
    ds_read_b32 v6, v5 offset:0
    s_waitcnt lgkmcnt(0)
    v_cmp_gt_u32 vcc, 9, v6
    s_cbranch_vccnz L_pa9
    s_load_dword s14, s[4:5], 0 glc
    s_load_dword s14, s[4:5], 256 glc
    s_load_dword s14, s[4:5], 512 glc
    s_load_dword s14, s[4:5], 768 glc
    s_lshl_b32 s3, s42, 11
    s_add_u32 s3, s3, 0
    v_lshl_add_u32 v42, v0, 4, s3
    s_lshl_b32 s3, s11, 14
    s_add_u32 s3, s3, 25165824
    v_and_b32 v72, 15, v0
    v_lshl_add_u32 v72, v72, 4, s3
    v_lshrrev_b32 v43, 4, v0
    v_lshl_add_u32 v43, v43, 9, v72
    s_lshl2_add_u32 s81, s41, s40
    s_lshl_b32 s81, s81, 7
    s_lshl_b32 s3, s10, 16
    s_add_u32 s3, s3, s81
    v_and_b32 v72, 31, v0
    v_lshl_add_u32 v72, v72, 2, s3
    v_lshrrev_b32 v44, 5, v0
    v_lshl_add_u32 v44, v44, 13, v72
    v_mov_b32 v2, s43
    v_lshlrev_b32 v3, 2, v0
    s_waitcnt vmcnt(0)
    s_mov_b32 exec_hi, 0
    buffer_store_dword v2, v3, s[44:47], s35 offen sc1
    s_mov_b64 exec, -1
    v_mov_b32 v6, 11
    ds_write_b32 v4, v6 offset:0
    s_add_u32 s73, s12, 5
    s_sub_u32 s3, s73, 11
    s_cselect_b32 s73, s73, s3
    s_lshl_b32 s73, s73, 15
    s_add_u32 m0, s22, 98304
    s_nop 0
    buffer_load_dwordx4 v40, s[64:67], s73 offen lds
    s_add_u32 m0, s22, 99328
    s_nop 0
    buffer_load_dwordx4 v41, s[64:67], s73 offen lds
    s_add_u32 s73, s12, 6
    s_sub_u32 s3, s73, 11
    s_cselect_b32 s73, s73, s3
    s_lshl_b32 s73, s73, 15
    s_add_u32 m0, s22, 106496
    s_nop 0
    buffer_load_dwordx4 v40, s[64:67], s73 offen lds
    s_add_u32 m0, s22, 107520
    s_nop 0
    buffer_load_dwordx4 v41, s[64:67], s73 offen lds
    s_add_u32 s73, s12, 7
    s_sub_u32 s3, s73, 11
    s_cselect_b32 s73, s73, s3
    s_lshl_b32 s73, s73, 15
    s_add_u32 m0, s22, 114688
    s_nop 0
    buffer_load_dwordx4 v40, s[64:67], s73 offen lds
    s_add_u32 m0, s22, 115712
    s_nop 0
    buffer_load_dwordx4 v41, s[64:67], s73 offen lds
    s_add_u32 s73, s12, 8
    s_sub_u32 s3, s73, 11
    s_cselect_b32 s73, s73, s3
    s_lshl_b32 s73, s73, 15
    s_add_u32 m0, s22, 122880
    s_nop 0
    buffer_load_dwordx4 v40, s[64:67], s73 offen lds
    s_add_u32 m0, s22, 123904
    s_nop 0
    buffer_load_dwordx4 v41, s[64:67], s73 offen lds
    s_add_u32 s73, s12, 9
    s_sub_u32 s3, s73, 11
    s_cselect_b32 s73, s73, s3
    s_lshl_b32 s73, s73, 15
    s_add_u32 m0, s22, 131072
    s_nop 0
    buffer_load_dwordx4 v40, s[64:67], s73 offen lds
    s_add_u32 m0, s22, 132096
    s_nop 0
    buffer_load_dwordx4 v41, s[64:67], s73 offen lds
    s_add_u32 s73, s12, 10
    s_sub_u32 s3, s73, 11
    s_cselect_b32 s73, s73, s3
    s_lshl_b32 s73, s73, 15
    s_add_u32 m0, s22, 139264
    s_nop 0
    buffer_load_dwordx4 v40, s[64:67], s73 offen lds
    s_add_u32 m0, s22, 140288
    s_nop 0
    buffer_load_dwordx4 v41, s[64:67], s73 offen lds
    s_add_u32 m0, s26, 48
    s_mov_b64 exec, 1
    buffer_load_dword off, s[28:31], 52 lds
    s_mov_b64 exec, -1
    s_mov_b32 s88, 32768
L_gu_try:
    s_load_dword s56, s[4:5], 0 glc
    s_load_dword s57, s[4:5], 256 glc
    s_load_dword s58, s[4:5], 512 glc
    s_load_dword s59, s[4:5], 768 glc
L_gu_wait:
    s_waitcnt lgkmcnt(0)
    s_xor_b32 s56, s56, s43
    s_xor_b32 s57, s57, s43
    s_or_b32 s56, s56, s57
    s_xor_b32 s58, s58, s43
    s_or_b32 s56, s56, s58
    s_xor_b32 s59, s59, s43
    s_or_b32 s56, s56, s59
    s_cbranch_scc0 L_gu_ok
    s_sub_u32 s88, s88, 1
    s_cmp_lg_u32 s88, 0
    s_cbranch_scc1 L_gu_try
L_gu_ok:
    v_mov_b32 v6, 12
    ds_write_b32 v4, v6 offset:0
    s_load_dword s14, s[6:7], 256 glc
    s_load_dword s14, s[6:7], 512 glc
    s_load_dword s14, s[6:7], 768 glc
    s_setprio 0
    s_barrier
    ds_read_b128 v[32:35], v42 offset:0
    ds_read_b128 v[36:39], v42 offset:1024
    s_mov_b32 s88, 32768
L_pp_try:
    s_load_dword s56, s[6:7], 256 glc
    s_load_dword s57, s[6:7], 512 glc
    s_load_dword s58, s[6:7], 768 glc
L_pp_wait:
    s_waitcnt lgkmcnt(0)
    s_xor_b32 s56, s56, s43
    s_xor_b32 s57, s57, s43
    s_or_b32 s56, s56, s57
    s_xor_b32 s58, s58, s43
    s_or_b32 s56, s56, s58
    s_cbranch_scc0 L_pp_ok
    s_sub_u32 s88, s88, 1
    s_cmp_lg_u32 s88, 0
    s_cbranch_scc1 L_pp_try
L_pp_ok:
    v_mov_b32 v6, 14
    ds_write_b32 v4, v6 offset:0
    buffer_load_dwordx4 v[48:51], v43, s[44:47], s74 offen offset:0 sc1
    buffer_load_dwordx4 v[52:55], v43, s[44:47], s75 offen offset:0 sc1
    buffer_load_dwordx4 v[56:59], v43, s[44:47], s76 offen offset:0 sc1
    s_waitcnt vmcnt(2)
    v_lshlrev_b32 v60, 16, v48
    v_and_b32 v61, 0xffff0000, v48
    v_lshlrev_b32 v62, 16, v49
    v_and_b32 v63, 0xffff0000, v49
    v_lshlrev_b32 v64, 16, v50
    v_and_b32 v65, 0xffff0000, v50
    v_lshlrev_b32 v66, 16, v51
    v_and_b32 v67, 0xffff0000, v51
    v_pk_add_f32 v[32:33], v[32:33], v[60:61]
    v_pk_add_f32 v[34:35], v[34:35], v[62:63]
    v_pk_add_f32 v[36:37], v[36:37], v[64:65]
    v_pk_add_f32 v[38:39], v[38:39], v[66:67]
    s_waitcnt vmcnt(1)
    v_lshlrev_b32 v60, 16, v52
    v_and_b32 v61, 0xffff0000, v52
    v_lshlrev_b32 v62, 16, v53
    v_and_b32 v63, 0xffff0000, v53
    v_lshlrev_b32 v64, 16, v54
    v_and_b32 v65, 0xffff0000, v54
    v_lshlrev_b32 v66, 16, v55
    v_and_b32 v67, 0xffff0000, v55
    v_pk_add_f32 v[32:33], v[32:33], v[60:61]
    v_pk_add_f32 v[34:35], v[34:35], v[62:63]
    v_pk_add_f32 v[36:37], v[36:37], v[64:65]
    v_pk_add_f32 v[38:39], v[38:39], v[66:67]
    s_waitcnt vmcnt(0)
    v_lshlrev_b32 v60, 16, v56
    v_and_b32 v61, 0xffff0000, v56
    v_lshlrev_b32 v62, 16, v57
    v_and_b32 v63, 0xffff0000, v57
    v_lshlrev_b32 v64, 16, v58
    v_and_b32 v65, 0xffff0000, v58
    v_lshlrev_b32 v66, 16, v59
    v_and_b32 v67, 0xffff0000, v59
    v_pk_add_f32 v[32:33], v[32:33], v[60:61]
    v_pk_add_f32 v[34:35], v[34:35], v[62:63]
    v_pk_add_f32 v[36:37], v[36:37], v[64:65]
    v_pk_add_f32 v[38:39], v[38:39], v[66:67]
    s_nop 0
    v_permlane16_swap_b32 v32, v36
    buffer_store_dword v32, v44, s[68:71], 0 offen offset:0 nt
    buffer_store_dword v36, v44, s[68:71], s24 offen offset:0 nt
    v_permlane16_swap_b32 v33, v37
    buffer_store_dword v33, v44, s[68:71], 0 offen offset:2048 nt
    buffer_store_dword v37, v44, s[68:71], s24 offen offset:2048 nt
    v_permlane16_swap_b32 v34, v38
    buffer_store_dword v34, v44, s[68:71], s74 offen offset:0 nt
    buffer_store_dword v38, v44, s[68:71], s25 offen offset:0 nt
    v_permlane16_swap_b32 v35, v39
    buffer_store_dword v35, v44, s[68:71], s74 offen offset:2048 nt
    buffer_store_dword v39, v44, s[68:71], s25 offen offset:2048 nt
    s_cmp_lg_u32 s11, 960
    s_cbranch_scc1 L_p1_done
    v_mov_b32 v1, s43
    v_mov_b32 v2, 22020096
    s_mov_b64 exec, 1
    buffer_store_dword v1, v2, s[44:47], 0 offen sc1
    s_mov_b64 exec, -1
L_p1_done:
    s_endpgm
L_j3:
    v_mov_b32 v6, 10
    ds_write_b32 v4, v6 offset:0
    s_branch L_no_u2
L_slow1:
    ds_read_b32 v6, v5 offset:48
    s_waitcnt lgkmcnt(0)
    v_cmp_gt_u32 vcc, 1, v6
    s_cbranch_vccnz L_slow1
    s_branch L_back1
L_slow2:
    ds_read_b32 v6, v5 offset:48
    s_waitcnt lgkmcnt(0)
    v_cmp_gt_u32 vcc, 2, v6
    s_cbranch_vccnz L_slow2
    s_branch L_back2
L_slow3:
    ds_read_b32 v6, v5 offset:16
    s_waitcnt lgkmcnt(0)
    v_cmp_gt_u32 vcc, 3, v6
    s_cbranch_vccnz L_slow3
    s_branch L_back3
L_slow4:
    ds_read_b32 v6, v5 offset:16
    s_waitcnt lgkmcnt(0)
    v_cmp_gt_u32 vcc, 4, v6
    s_cbranch_vccnz L_slow4
    s_branch L_back4
L_slow5:
    ds_read_b32 v6, v5 offset:16
    s_waitcnt lgkmcnt(0)
    v_cmp_gt_u32 vcc, 5, v6
    s_cbranch_vccnz L_slow5
    s_branch L_back5
L_slow6:
    ds_read_b32 v6, v5 offset:16
    s_waitcnt lgkmcnt(0)
    v_cmp_gt_u32 vcc, 6, v6
    s_cbranch_vccnz L_slow6
    s_branch L_back6
L_slow7:
    ds_read_b32 v6, v5 offset:16
    s_waitcnt lgkmcnt(0)
    v_cmp_gt_u32 vcc, 7, v6
    s_cbranch_vccnz L_slow7
    s_branch L_back7
L_p2:
    s_and_b32 s3, s39, 3
    s_mov_b32 s87, 1984246288
    s_cmp_eq_u32 s3, 1
    s_cselect_b32 s87, 1969500448, s87
    s_cmp_eq_u32 s3, 2
    s_cselect_b32 s87, 1733567248, s87
    s_cmp_eq_u32 s3, 3
    s_cselect_b32 s87, 1985167888, s87
    s_and_b32 s3, s2, 6
    s_add_u32 s3, s3, s38
    s_and_b32 s3, s3, 7
    s_mul_i32 s3, s3, 0x11111111
    s_add_u32 s87, s87, s3
    v_and_b32 v116, 15, v0
    v_lshlrev_b32 v116, 2, v116
    v_add_u32 v116, 157696, v116
    v_mov_b32 v118, 0
    ds_write_b32 v116, v118
    v_and_b32 v136, 31, v0
    v_bfe_u32 v120, v0, 1, 3
    v_lshrrev_b32 v137, 5, v0
    v_xor_b32 v120, v120, v137
    v_lshlrev_b32 v120, 4, v120
    v_lshl_add_u32 v136, v136, 7, v120
    v_xor_b32 v137, 32, v136
    v_xor_b32 v138, 64, v136
    v_xor_b32 v139, 96, v136
    s_lshl_b32 s82, s42, 12
    v_add_u32 v128, s82, v136
    v_add_u32 v132, 49152, v128
    v_add_u32 v140, 49152, v136
    v_add_u32 v129, s82, v137
    v_add_u32 v133, 49152, v129
    v_add_u32 v141, 49152, v137
    v_add_u32 v130, s82, v138
    v_add_u32 v134, 49152, v130
    v_add_u32 v142, 49152, v138
    v_add_u32 v131, s82, v139
    v_add_u32 v135, 49152, v131
    v_add_u32 v143, 49152, v139
    s_waitcnt lgkmcnt(0)
    s_add_u32 s0, s36, 22020096
    s_addc_u32 s1, s37, 0
    s_load_dword s43, s[0:1], 0
    s_lshr_b32 s40, s39, 2
    s_and_b32 s41, s39, 3
    s_mul_i32 s12, s41, 3
    s_lshl2_add_u32 s10, s38, s42
    s_lshl4_add_u32 s11, s10, s39
    s_mov_b32 s68, s28
    s_mov_b32 s69, s29
    s_mov_b32 s70, 1409024
    s_mov_b32 s71, 0x20000
    s_mov_b32 s56, s24
    s_mov_b32 s57, s25
    s_mov_b32 s58, 1409024
    s_mov_b32 s59, 0x20000
    s_mov_b32 s60, s26
    s_mov_b32 s61, s27
    s_mov_b32 s62, 1409024
    s_mov_b32 s63, 0x20000
    s_mov_b32 s44, s36
    s_mov_b32 s45, s37
    s_mov_b32 s46, 41943040
    s_mov_b32 s47, 0x20000
    s_mov_b32 s48, s4
    s_mov_b32 s49, s5
    s_mov_b32 s50, 2097152
    s_mov_b32 s51, 0x20000
    s_mov_b32 s52, s14
    s_mov_b32 s53, s15
    s_mov_b32 s54, 524288
    s_mov_b32 s55, 0x20000
    s_mov_b32 s64, s16
    s_mov_b32 s65, s17
    s_mov_b32 s66, 524288
    s_mov_b32 s67, 0x20000
    s_mov_b32 s74, 4096
    s_mov_b32 s75, 8192
    s_mov_b32 s76, 12288
    s_mov_b32 s77, 16384
    s_mov_b32 s78, 20480
    s_mov_b32 s79, 24576
    s_mov_b32 s80, 28672
    s_mov_b32 s24, 32768
    s_mov_b32 s25, 36864
    s_lshr_b32 s3, s39, 2
    s_mul_i32 s27, s39, 3
    s_sub_u32 s27, s27, s3
    v_and_b32 v112, 0x13, v0
    v_bfe_u32 v120, v0, 2, 1
    v_lshl_add_u32 v112, v120, 3, v112
    v_bfe_u32 v120, v0, 3, 1
    v_lshl_add_u32 v112, v120, 2, v112
    v_lshlrev_b32 v112, 1, v112
    v_add_u32 v112, 158720, v112
    s_mul_i32 s3, s42, 44032
    s_lshl_b32 s81, s27, 6
    s_add_u32 s3, s3, s81
    s_and_b32 s81, s39, 3
    s_cmp_eq_u32 s81, 3
    s_cselect_b32 s81, 8, 12
    s_cmp_eq_u32 s39, 15
    s_cselect_b32 s81, 4, s81
    v_mov_b32 v123, 1073741824
    v_add_u32 v120, 0, v0
    v_mul_u32_u24 v121, 171, v120
    v_lshrrev_b32 v121, 11, v121
    v_mul_u32_u24 v122, 12, v121
    v_sub_u32 v120, v120, v122
    v_cmp_gt_i32 vcc, s81, v120
    v_lshrrev_b32 v122, 2, v121
    v_and_b32 v122, 2, v122
    v_xor_b32 v120, v120, v122
    v_mul_u32_u24 v121, 2752, v121
    v_lshl_add_u32 v121, v120, 4, v121
    v_add_u32 v121, s3, v121
    v_cndmask_b32 v104, v123, v121, vcc
    v_add_u32 v120, 64, v0
    v_mul_u32_u24 v121, 171, v120
    v_lshrrev_b32 v121, 11, v121
    v_mul_u32_u24 v122, 12, v121
    v_sub_u32 v120, v120, v122
    v_cmp_gt_i32 vcc, s81, v120
    v_lshrrev_b32 v122, 2, v121
    v_and_b32 v122, 2, v122
    v_xor_b32 v120, v120, v122
    v_mul_u32_u24 v121, 2752, v121
    v_lshl_add_u32 v121, v120, 4, v121
    v_subrev_u32 v121, 1024, v121
    v_add_u32 v121, s3, v121
    v_cndmask_b32 v105, v123, v121, vcc
    v_add_u32 v120, 128, v0
    v_mul_u32_u24 v121, 171, v120
    v_lshrrev_b32 v121, 11, v121
    v_mul_u32_u24 v122, 12, v121
    v_sub_u32 v120, v120, v122
    v_cmp_gt_i32 vcc, s81, v120
    v_lshrrev_b32 v122, 2, v121
    v_and_b32 v122, 2, v122
    v_xor_b32 v120, v120, v122
    v_mul_u32_u24 v121, 2752, v121
    v_lshl_add_u32 v121, v120, 4, v121
    v_subrev_u32 v121, 2048, v121
    v_add_u32 v121, s3, v121
    v_cndmask_b32 v106, v123, v121, vcc
    s_mul_i32 s83, s42, 3072
    v_and_b32 v109, 31, v0
    v_lshlrev_b32 v109, 4, v109
    v_add_u32 v109, 155648, v109
    s_lshl_b32 s3, s42, 9
    v_add_u32 v110, s3, v109
    s_lshl_b32 s3, s42, 2
    s_lshl_b32 s81, s39, 14
    s_add_u32 s81, s81, 20971520
    v_and_b32 v120, 15, v0
    v_lshl_add_u32 v120, v120, 4, s81
    v_bfe_u32 v123, v0, 4, 1
    v_lshl_add_u32 v120, v123, 9, v120
    v_lshrrev_b32 v123, 5, v0
    v_mov_b32 v122, 1073741824
    v_add_u32 v121, s3, v123
    v_cmp_gt_u32 vcc, s38, v121
    v_lshl_add_u32 v107, v121, 10, v120
    v_sub_u32 v116, s38, v121
    v_cndmask_b32 v107, v122, v107, vcc
    v_add_u32 v116, -1, v116
    v_max_i32 v116, 0, v116
    v_lshlrev_b32 v116, 7, v116
    v_cvt_f32_i32 v116, v116
    v_add_u32 v121, s3, v123
    v_add_u32 v121, 2, v121
    v_cmp_gt_u32 vcc, s38, v121
    v_lshl_add_u32 v108, v121, 10, v120
    v_sub_u32 v117, s38, v121
    v_cndmask_b32 v108, v122, v108, vcc
    v_add_u32 v117, -1, v117
    v_max_i32 v117, 0, v117
    v_lshlrev_b32 v117, 7, v117
    v_cvt_f32_i32 v117, v117
    s_lshl_b32 s3, s42, 5
    v_lshl_add_u32 v118, v123, 4, s3
    v_cvt_f32_i32 v118, v118
    s_lshl4_add_u32 s3, s39, s38
    s_lshl_b32 s3, s3, 10
    s_add_u32 s3, s3, 20971520
    s_cmp_eq_u32 s42, 0
    s_cselect_b32 s3, s3, 1073741824
    v_and_b32 v120, 15, v0
    v_lshl_add_u32 v120, v120, 4, s3
    v_lshrrev_b32 v111, 4, v0
    v_lshl_add_u32 v111, v111, 9, v120
    s_lshl2_add_u32 s3, s42, 157712
    v_mov_b32 v15, s3
    v_and_b32 v16, 3, v0
    v_lshlrev_b32 v16, 2, v16
    v_add_u32 v16, 157696, v16
    s_lshl_b32 s3, s2, 4
    s_mul_i32 s81, s2, 43
    s_and_b32 s0, s42, 1
    s_mul_i32 s0, s0, 22
    s_add_u32 s81, s81, s0
    s_cmp_ge_u32 s42, 2
    s_cselect_b32 s3, s81, s3
    s_cselect_b32 s81, 21, 15
    s_lshl_b32 s3, s3, 7
    v_min_u32 v8, s81, v0
    v_lshl_add_u32 v8, v8, 7, s3
    s_cmp_eq_u32 s42, 1
    s_cselect_b32 s16, s16, s14
    s_cselect_b32 s17, s17, s15
    s_cmp_ge_u32 s42, 2
    s_cselect_b32 s16, s28, s16
    s_cselect_b32 s17, s29, s17
    s_cselect_b32 s18, s70, s54
    s_mov_b32 s19, 0x20000
    s_lshl2_add_u32 s81, s41, s40
    s_lshl_b32 s81, s81, 6
    v_and_b32 v121, 15, v0
    v_lshl_add_u32 v28, v121, 1, s81
    v_add_u32 v28, 160768, v28
    s_add_u32 s28, s84, L_tab-L_pc
    s_addc_u32 s29, s85, 0
    s_mov_b32 s30, 64
    s_mov_b32 s31, 0x20000
    s_lshl2_add_u32 s26, s42, 157696
    s_waitcnt lgkmcnt(0)
    s_add_u32 s43, s43, 0x9E3779B1
    s_barrier
    ds_read_b128 v[144:147], v128 offset:0
    ds_read_b128 v[160:163], v136 offset:16384
    ds_read_b128 v[164:167], v136 offset:20480
    ds_read_b128 v[148:151], v129 offset:0
    ds_read_b128 v[168:171], v137 offset:16384
    ds_read_b128 v[172:175], v137 offset:20480
    ds_read_b128 v[152:155], v130 offset:0
    ds_read_b128 v[176:179], v138 offset:16384
    ds_read_b128 v[180:183], v138 offset:20480
    ds_read_b128 v[156:159], v131 offset:0
    ds_read_b128 v[184:187], v139 offset:16384
    ds_read_b128 v[188:191], v139 offset:20480
    s_waitcnt lgkmcnt(10)
    v_mfma_f32_32x32x16_bf16 v[32:47], v[144:147], v[160:163], 0
    s_lshl_b32 s35, s11, 8
    s_add_u32 s35, s35, 21495808
    s_and_b32 s3, s11, -4
    s_lshl_b32 s3, s3, 8
    s_add_u32 s3, s3, 21495808
    s_waitcnt lgkmcnt(9)
    v_mfma_f32_32x32x16_bf16 v[48:63], v[144:147], v[164:167], 0
    s_add_u32 s4, s36, s3
    s_addc_u32 s5, s37, 0
    s_lshl_b32 s3, s11, 10
    s_add_u32 s3, s3, 23068672
    s_add_u32 s6, s36, s3
    s_waitcnt lgkmcnt(7)
    v_mfma_f32_32x32x16_bf16 v[32:47], v[148:151], v[168:171], v[32:47]
    s_addc_u32 s7, s37, 0
    v_bfe_u32 v120, v0, 3, 2
    v_bfe_u32 v121, v0, 1, 1
    v_lshl_add_u32 v120, v120, 1, v121
    v_bfe_u32 v121, v0, 2, 1
    s_waitcnt lgkmcnt(6)
    v_mfma_f32_32x32x16_bf16 v[48:63], v[148:151], v[172:175], v[48:63]
    v_lshrrev_b32 v122, 5, v0
    v_xor_b32 v121, v121, v122
    v_lshl_add_u32 v120, v121, 3, v120
    v_and_b32 v121, 1, v0
    v_lshlrev_b32 v121, 4, v121
    s_waitcnt lgkmcnt(0)
    v_mov_b32 v122, 0xffff
    v_lshlrev_b32 v121, v121, v122
    v_cmp_eq_u32 vcc, 0, v120
    v_cmp_eq_u32 s[8:9], 1, v120
    s_nop 0
    v_cndmask_b32 v96, 0, v121, vcc
    v_cndmask_b32 v97, 0, v121, s[8:9]
    v_cmp_eq_u32 vcc, 2, v120
    v_cmp_eq_u32 s[8:9], 3, v120
    s_nop 0
    v_cndmask_b32 v98, 0, v121, vcc
    v_cndmask_b32 v99, 0, v121, s[8:9]
    v_cmp_eq_u32 vcc, 4, v120
    v_cmp_eq_u32 s[8:9], 5, v120
    s_nop 0
    v_cndmask_b32 v100, 0, v121, vcc
    v_cndmask_b32 v101, 0, v121, s[8:9]
    v_cmp_eq_u32 vcc, 6, v120
    v_cmp_eq_u32 s[8:9], 7, v120
    s_nop 0
    v_cndmask_b32 v102, 0, v121, vcc
    v_cndmask_b32 v103, 0, v121, s[8:9]
    s_mul_i32 s81, s10, 160
    s_and_b32 s3, s39, 14
    s_lshl2_add_u32 s81, s3, s81
    s_and_b32 s3, s39, 1
    s_lshl1_add_u32 s81, s3, s81
    s_lshl_b32 s81, s81, 11
    v_and_b32 v120, 15, v0
    v_lshl_add_u32 v120, v120, 4, s81
    v_bfe_u32 v121, v0, 4, 1
    v_lshl_add_u32 v120, v121, 11, v120
    v_lshrrev_b32 v121, 5, v0
    v_lshl_add_u32 v7, v121, 9, v120
    v_lshrrev_b32 v120, 3, v0
    v_lshrrev_b32 v123, 4, v0
    v_and_b32 v121, 7, v0
    v_xor_b32 v121, v121, v123
    v_lshlrev_b32 v121, 4, v121
    v_xor_b32 v122, 64, v121
    s_xor_b32 s3, s42, s40
    s_lshl2_add_u32 s3, s41, s3
    s_lshl_b32 s3, s3, 15
    s_lshl_b32 s81, s40, 8
    s_add_u32 s3, s3, s81
    v_lshl_add_u32 v123, v120, 10, s3
    v_add_u32 v1, v123, v121
    v_add_u32 v2, v123, v122
    v_add_u32 v3, 14336, v1
    v_add_u32 v4, 21504, v2
    s_barrier
    ds_read_b128 v[192:195], v128 offset:24576
    ds_read_b128 v[208:211], v136 offset:40960
    ds_read_b128 v[212:215], v136 offset:45056
    v_mfma_f32_32x32x16_bf16 v[32:47], v[152:155], v[176:179], v[32:47]
    v_add_u32 v2, 7168, v2
    v_lshrrev_b32 v120, 3, v0
    v_and_b32 v121, 6, v120
    v_and_b32 v5, 7, v0
    v_xor_b32 v121, v121, v5
    v_mfma_f32_32x32x16_bf16 v[48:63], v[152:155], v[180:183], v[48:63]
    v_lshlrev_b32 v121, 4, v121
    v_lshl_add_u32 v120, v120, 10, v121
    ds_read_b128 v[196:199], v129 offset:24576
    ds_read_b128 v[216:219], v137 offset:40960
    ds_read_b128 v[220:223], v137 offset:45056
    v_mfma_f32_32x32x16_bf16 v[32:47], v[156:159], v[184:187], v[32:47]
    s_mul_i32 s3, s40, 44
    s_add_u32 s3, s3, s42
    s_lshl_b32 s3, s3, 13
    s_lshr_b32 s81, s40, 1
    s_lshl1_add_u32 s81, s41, s81
    v_mfma_f32_32x32x16_bf16 v[48:63], v[156:159], v[188:191], v[48:63]
    s_lshl_b32 s81, s81, 7
    s_add_u32 s3, s3, s81
    ds_read_b128 v[200:203], v130 offset:24576
    ds_read_b128 v[224:227], v138 offset:40960
    ds_read_b128 v[228:231], v138 offset:45056
    ds_read_b128 v[204:207], v131 offset:24576
    ds_read_b128 v[232:235], v139 offset:40960
    ds_read_b128 v[236:239], v139 offset:45056
    ds_read_u16 v113, v112 offset:0
    ds_read_u16 v114, v112 offset:256
    ds_read_u16 v115, v112 offset:512
    s_waitcnt lgkmcnt(13)
    v_mfma_f32_32x32x16_bf16 v[32:47], v[192:195], v[208:211], v[32:47]
    v_add_u32 v5, s3, v120
    v_xor_b32 v6, 0x80, v5
    s_lshl_b32 s22, s42, 11
    v_bfe_u32 v120, v0, 1, 3
    v_lshrrev_b32 v11, 4, v0
    s_waitcnt lgkmcnt(12)
    v_mfma_f32_32x32x16_bf16 v[48:63], v[192:195], v[212:215], v[48:63]
    v_xor_b32 v120, v120, v11
    v_lshlrev_b32 v120, 4, v120
    v_and_b32 v11, 15, v0
    v_lshl_add_u32 v11, v11, 7, v120
    v_xor_b32 v12, 64, v11
    s_waitcnt lgkmcnt(10)
    v_mfma_f32_32x32x16_bf16 v[32:47], v[196:199], v[216:219], v[32:47]
    v_add_u32 v11, 0, v11
    v_add_u32 v12, 0, v12
    s_mul_i32 s3, s10, 160
    s_mul_i32 s81, s40, 16
    s_add_u32 s3, s3, s81
    s_waitcnt lgkmcnt(9)
    v_mfma_f32_32x32x16_bf16 v[48:63], v[196:199], v[220:223], v[48:63]
    s_add_u32 s3, s3, 0
    s_lshl_b32 s3, s3, 11
    v_and_b32 v120, 15, v0
    v_lshl_add_u32 v120, v120, 4, s3
    v_lshrrev_b32 v18, 4, v0
    s_waitcnt lgkmcnt(0)
    s_barrier
    ds_read_b128 v[144:147], v132 offset:0
    ds_read_b128 v[160:163], v140 offset:16384
    ds_read_b128 v[164:167], v140 offset:20480
    v_mfma_f32_32x32x16_bf16 v[32:47], v[200:203], v[224:227], v[32:47]
    v_lshl_add_u32 v18, v18, 9, v120
    s_lshl_b32 s3, s42, 11
    s_add_u32 s3, s3, 0
    v_lshl_add_u32 v19, v0, 4, s3
    v_bfe_u32 v121, v0, 3, 2
    v_mfma_f32_32x32x16_bf16 v[48:63], v[200:203], v[228:231], v[48:63]
    s_and_b32 s3, s40, 1
    s_lshl_b32 s3, s3, 1
    ds_read_b128 v[148:151], v133 offset:0
    ds_read_b128 v[168:171], v141 offset:16384
    ds_read_b128 v[172:175], v141 offset:20480
    v_mfma_f32_32x32x16_bf16 v[32:47], v[204:207], v[232:235], v[32:47]
    v_xor_b32 v121, s3, v121
    v_lshlrev_b32 v121, 5, v121
    v_bfe_u32 v120, v0, 2, 3
    v_lshl_add_u32 v120, v120, 7, v121
    v_and_b32 v121, 3, v0
    v_mfma_f32_32x32x16_bf16 v[48:63], v[204:207], v[236:239], v[48:63]
    v_lshl_add_u32 v120, v121, 3, v120
    v_lshrrev_b32 v121, 5, v0
    ds_read_b128 v[152:155], v134 offset:0
    ds_read_b128 v[176:179], v142 offset:16384
    ds_read_b128 v[180:183], v142 offset:20480
    ds_read_b128 v[156:159], v135 offset:0
    ds_read_b128 v[184:187], v143 offset:16384
    ds_read_b128 v[188:191], v143 offset:20480
    ds_read_u16 v29, v28 offset:32
    ds_read_u16 v28, v28
    s_waitcnt lgkmcnt(12)
    v_mfma_f32_32x32x16_bf16 v[32:47], v[144:147], v[160:163], v[32:47]
    v_lshl_add_u32 v240, v121, 11, v120
    v_add_u32 v240, 49152, v240
    v_add_u32 v244, 49152, v240
    v_xor_b32 v241, 32, v240
    v_add_u32 v245, 49152, v241
    s_waitcnt lgkmcnt(11)
    v_mfma_f32_32x32x16_bf16 v[48:63], v[144:147], v[164:167], v[48:63]
    v_xor_b32 v242, 64, v240
    v_add_u32 v246, 49152, v242
    v_xor_b32 v243, 96, v240
    v_add_u32 v247, 49152, v243
    s_mul_i32 s3, s10, 160
    s_waitcnt lgkmcnt(9)
    v_mfma_f32_32x32x16_bf16 v[32:47], v[148:151], v[168:171], v[32:47]
    s_mul_i32 s81, s40, 22
    s_add_u32 s3, s3, s81
    s_add_u32 s3, s3, 64
    s_lshl_b32 s3, s3, 11
    v_and_b32 v120, 15, v0
    s_waitcnt lgkmcnt(8)
    v_mfma_f32_32x32x16_bf16 v[48:63], v[148:151], v[172:175], v[48:63]
    v_lshl_add_u32 v120, v120, 4, s3
    v_lshrrev_b32 v27, 4, v0
    v_lshl_add_u32 v27, v27, 9, v120
    s_lshl_b32 s3, s42, 7
    s_add_u32 s3, s3, 157952
    s_waitcnt lgkmcnt(0)
    s_barrier
    ds_read_b128 v[192:195], v132 offset:24576
    ds_read_b128 v[208:211], v140 offset:40960
    ds_read_b128 v[212:215], v140 offset:45056
    v_mfma_f32_32x32x16_bf16 v[32:47], v[152:155], v[176:179], v[32:47]
    v_lshrrev_b32 v20, 4, v0
    v_lshl_add_u32 v20, v20, 4, s3
    s_lshl2_add_u32 s81, s41, s40
    s_lshl_b32 s81, s81, 7
    s_lshl_b32 s3, s10, 16
    v_mfma_f32_32x32x16_bf16 v[48:63], v[152:155], v[180:183], v[48:63]
    s_add_u32 s3, s3, s81
    s_add_u32 s3, s3, 16384
    ds_read_b128 v[196:199], v133 offset:24576
    ds_read_b128 v[216:219], v141 offset:40960
    ds_read_b128 v[220:223], v141 offset:45056
    v_mfma_f32_32x32x16_bf16 v[32:47], v[156:159], v[184:187], v[32:47]
    v_and_b32 v120, 31, v0
    v_lshl_add_u32 v120, v120, 2, s3
    v_lshrrev_b32 v21, 5, v0
    v_lshl_add_u32 v21, v21, 13, v120
    s_lshl2_add_u32 s81, s41, s40
    v_mfma_f32_32x32x16_bf16 v[48:63], v[156:159], v[188:191], v[48:63]
    s_lshl_b32 s81, s81, 6
    v_and_b32 v121, 15, v0
    ds_read_b128 v[200:203], v134 offset:24576
    ds_read_b128 v[224:227], v142 offset:40960
    ds_read_b128 v[228:231], v142 offset:45056
    ds_read_b128 v[204:207], v135 offset:24576
    ds_read_b128 v[232:235], v143 offset:40960
    ds_read_b128 v[236:239], v143 offset:45056
    s_waitcnt lgkmcnt(10)
    v_mfma_f32_32x32x16_bf16 v[32:47], v[192:195], v[208:211], v[32:47]
    s_lshl_b32 s3, s10, 15
    s_add_u32 s3, s3, s81
    v_and_b32 v120, 3, v0
    v_lshl_add_u32 v120, v120, 4, s3
    v_lshrrev_b32 v10, 2, v0
    s_waitcnt lgkmcnt(9)
    v_mfma_f32_32x32x16_bf16 v[48:63], v[192:195], v[212:215], v[48:63]
    v_lshl_add_u32 v10, v10, 10, v120
    v_bfe_u32 v13, v0, 4, 1
    v_lshrrev_b32 v120, 5, v0
    v_lshlrev_b32 v120, 2, v120
    v_lshl_add_u32 v13, v13, 4, v120
    s_waitcnt lgkmcnt(7)
    v_mfma_f32_32x32x16_bf16 v[32:47], v[196:199], v[216:219], v[32:47]
    s_add_u32 s3, s22, 147456
    v_lshl_add_u32 v121, v121, 1, s3
    v_lshl_add_u32 v13, v13, 6, v121
    s_lshl_b32 s3, s11, 14
    s_add_u32 s3, s3, 25165824
    s_waitcnt lgkmcnt(6)
    v_mfma_f32_32x32x16_bf16 v[48:63], v[196:199], v[220:223], v[48:63]
    v_and_b32 v120, 15, v0
    v_lshl_add_u32 v120, v120, 4, s3
    v_lshrrev_b32 v22, 4, v0
    v_lshl_add_u32 v22, v22, 9, v120
    v_xor_b32 v23, 69632, v22
    s_waitcnt lgkmcnt(0)
    s_barrier
    ds_read_b128 v[144:147], v128 offset:0
    ds_read_b128 v[160:163], v136 offset:16384
    ds_read_b128 v[164:167], v136 offset:20480
    v_mfma_f32_32x32x16_bf16 v[32:47], v[200:203], v[224:227], v[32:47]
    v_xor_b32 v24, 139264, v22
    v_xor_b32 v25, 208896, v22
    v_lshrrev_b32 v120, 4, v0
    v_mul_u32_u24 v120, 0x1100, v120
    s_lshl_b32 s3, s11, 10
    v_mfma_f32_32x32x16_bf16 v[48:63], v[200:203], v[228:231], v[48:63]
    v_xor_b32 v120, s3, v120
    v_and_b32 v26, 15, v0
    ds_read_b128 v[148:151], v129 offset:0
    ds_read_b128 v[168:171], v137 offset:16384
    ds_read_b128 v[172:175], v137 offset:20480
    v_mfma_f32_32x32x16_bf16 v[32:47], v[204:207], v[232:235], v[32:47]
    v_lshl_add_u32 v120, v26, 3, v120
    v_add_u32 v26, 23068672, v120
    v_lshlrev_b32 v113, 16, v113
    v_lshlrev_b32 v114, 16, v114
    v_lshlrev_b32 v115, 16, v115
    v_mfma_f32_32x32x16_bf16 v[48:63], v[204:207], v[236:239], v[48:63]
    v_mul_f32 v115, 1069066811, v115
    v_exp_f32 v115, v115
    ds_read_b128 v[152:155], v130 offset:0
    ds_read_b128 v[176:179], v138 offset:16384
    ds_read_b128 v[180:183], v138 offset:20480
    ds_read_b128 v[156:159], v131 offset:0
    ds_read_b128 v[184:187], v139 offset:16384
    ds_read_b128 v[188:191], v139 offset:20480
    s_waitcnt lgkmcnt(10)
    v_mfma_f32_32x32x16_bf16 v[32:47], v[144:147], v[160:163], v[32:47]
    s_nop 0
    v_cvt_pk_bf16_f32 v115, v115, v115
    v_lshlrev_b32 v115, 16, v115
    v_mul_f32 v119, v115, v113
    v_mul_f32 v124, v115, v114
    s_waitcnt lgkmcnt(9)
    v_mfma_f32_32x32x16_bf16 v[48:63], v[144:147], v[164:167], v[48:63]
    v_mul_f32 v119, 1069066811, v119
    v_mul_f32 v124, 1042479491, v124
    v_mul_f32 v120, 1.0, v119
    v_mul_f32 v121, 1.0, v124
    v_exp_f32 v120, v120
    s_waitcnt lgkmcnt(7)
    v_mfma_f32_32x32x16_bf16 v[32:47], v[148:151], v[168:171], v[32:47]
    v_fract_f32 v121, v121
    v_cos_f32 v80, v121
    v_sin_f32 v81, v121
    v_mul_f32 v80, v120, v80
    v_mul_f32 v81, v120, v81
    s_waitcnt lgkmcnt(6)
    v_mfma_f32_32x32x16_bf16 v[48:63], v[148:151], v[172:175], v[48:63]
    v_mul_f32 v120, 0x41800000, v119
    v_mul_f32 v121, 0x41800000, v124
    v_exp_f32 v120, v120
    v_fract_f32 v121, v121
    v_cos_f32 v82, v121
    s_waitcnt lgkmcnt(0)
    s_barrier
    ds_read_b128 v[192:195], v128 offset:24576
    ds_read_b128 v[208:211], v136 offset:40960
    ds_read_b128 v[212:215], v136 offset:45056
    v_mfma_f32_32x32x16_bf16 v[32:47], v[152:155], v[176:179], v[32:47]
    v_sin_f32 v83, v121
    v_mul_f32 v82, v120, v82
    v_mul_f32 v83, v120, v83
    v_mul_f32 v120, 0x42000000, v119
    v_mul_f32 v121, 0x42000000, v124
    v_mfma_f32_32x32x16_bf16 v[48:63], v[152:155], v[180:183], v[48:63]
    v_exp_f32 v120, v120
    v_fract_f32 v121, v121
    ds_read_b128 v[196:199], v129 offset:24576
    ds_read_b128 v[216:219], v137 offset:40960
    ds_read_b128 v[220:223], v137 offset:45056
    v_mfma_f32_32x32x16_bf16 v[32:47], v[156:159], v[184:187], v[32:47]
    v_cos_f32 v84, v121
    v_sin_f32 v85, v121
    v_mul_f32 v84, v120, v84
    v_mul_f32 v85, v120, v85
    v_mul_f32 v120, v116, v119
    v_mfma_f32_32x32x16_bf16 v[48:63], v[156:159], v[188:191], v[48:63]
    v_mul_f32 v121, v116, v124
    v_exp_f32 v120, v120
    ds_read_b128 v[200:203], v130 offset:24576
    ds_read_b128 v[224:227], v138 offset:40960
    ds_read_b128 v[228:231], v138 offset:45056
    ds_read_b128 v[204:207], v131 offset:24576
    ds_read_b128 v[232:235], v139 offset:40960
    ds_read_b128 v[236:239], v139 offset:45056
    s_waitcnt lgkmcnt(10)
    v_mfma_f32_32x32x16_bf16 v[32:47], v[192:195], v[208:211], v[32:47]
    v_fract_f32 v121, v121
    v_cos_f32 v90, v121
    v_sin_f32 v91, v121
    v_mul_f32 v90, v120, v90
    v_mul_f32 v91, v120, v91
    s_waitcnt lgkmcnt(9)
    v_mfma_f32_32x32x16_bf16 v[48:63], v[192:195], v[212:215], v[48:63]
    v_mul_f32 v120, v117, v119
    v_mul_f32 v121, v117, v124
    v_exp_f32 v120, v120
    v_fract_f32 v121, v121
    v_cos_f32 v92, v121
    s_waitcnt lgkmcnt(7)
    v_mfma_f32_32x32x16_bf16 v[32:47], v[196:199], v[216:219], v[32:47]
    v_sin_f32 v93, v121
    v_mul_f32 v92, v120, v92
    v_mul_f32 v93, v120, v93
    v_mul_f32 v120, v118, v119
    v_mul_f32 v121, v118, v124
    s_waitcnt lgkmcnt(6)
    v_mfma_f32_32x32x16_bf16 v[48:63], v[196:199], v[220:223], v[48:63]
    v_exp_f32 v120, v120
    v_fract_f32 v121, v121
    v_cos_f32 v94, v121
    v_sin_f32 v95, v121
    v_mul_f32 v94, v120, v94
    s_waitcnt lgkmcnt(0)
    s_barrier
    ds_read_b128 v[144:147], v132 offset:0
    ds_read_b128 v[160:163], v140 offset:16384
    ds_read_b128 v[164:167], v140 offset:20480
    v_mfma_f32_32x32x16_bf16 v[32:47], v[200:203], v[224:227], v[32:47]
    v_mul_f32 v95, v120, v95
    v_mul_f32 v120, v113, v113
    v_fmac_f32 v120, v114, v114
    v_rcp_f32 v120, v120
    v_add_f32 v121, -1.0, v80
    v_mfma_f32_32x32x16_bf16 v[48:63], v[200:203], v[228:231], v[48:63]
    v_add_f32 v120, v120, v120
    v_mul_f32 v86, v121, v113
    ds_read_b128 v[148:151], v133 offset:0
    ds_read_b128 v[168:171], v141 offset:16384
    ds_read_b128 v[172:175], v141 offset:20480
    v_mfma_f32_32x32x16_bf16 v[32:47], v[204:207], v[232:235], v[32:47]
    v_fmac_f32 v86, v81, v114
    v_mul_f32 v87, v81, v113
    v_fma_f32 v87, -v121, v114, v87
    v_mul_f32 v86, v120, v86
    v_mul_f32 v87, v120, v87
    v_mfma_f32_32x32x16_bf16 v[48:63], v[204:207], v[236:239], v[48:63]
    ds_read_b128 v[152:155], v134 offset:0
    ds_read_b128 v[176:179], v142 offset:16384
    ds_read_b128 v[180:183], v142 offset:20480
    ds_read_b128 v[156:159], v135 offset:0
    ds_read_b128 v[184:187], v143 offset:16384
    ds_read_b128 v[188:191], v143 offset:20480
    s_waitcnt lgkmcnt(10)
    v_mfma_f32_32x32x16_bf16 v[32:47], v[144:147], v[160:163], v[32:47]
    s_waitcnt lgkmcnt(9)
    v_mfma_f32_32x32x16_bf16 v[48:63], v[144:147], v[164:167], v[48:63]
    s_waitcnt lgkmcnt(7)
    v_mfma_f32_32x32x16_bf16 v[32:47], v[148:151], v[168:171], v[32:47]
    s_waitcnt lgkmcnt(6)
    v_mfma_f32_32x32x16_bf16 v[48:63], v[148:151], v[172:175], v[48:63]
    s_waitcnt lgkmcnt(0)
    s_setprio 3
    s_barrier
    ds_read_b128 v[192:195], v132 offset:24576
    ds_read_b128 v[208:211], v140 offset:40960
    ds_read_b128 v[212:215], v140 offset:45056
    v_mfma_f32_32x32x16_bf16 v[32:47], v[152:155], v[176:179], v[32:47]
    v_mfma_f32_32x32x16_bf16 v[48:63], v[152:155], v[180:183], v[48:63]
    ds_read_b128 v[196:199], v133 offset:24576
    ds_read_b128 v[216:219], v141 offset:40960
    ds_read_b128 v[220:223], v141 offset:45056
    v_mfma_f32_32x32x16_bf16 v[32:47], v[156:159], v[184:187], v[32:47]
    v_mfma_f32_32x32x16_bf16 v[48:63], v[156:159], v[188:191], v[48:63]
    ds_read_b128 v[200:203], v134 offset:24576
    ds_read_b128 v[224:227], v142 offset:40960
    ds_read_b128 v[228:231], v142 offset:45056
    ds_read_b128 v[204:207], v135 offset:24576
    ds_read_b128 v[232:235], v143 offset:40960
    ds_read_b128 v[236:239], v143 offset:45056
    s_waitcnt lgkmcnt(10)
    v_mfma_f32_32x32x16_bf16 v[32:47], v[192:195], v[208:211], v[32:47]
    s_waitcnt lgkmcnt(9)
    v_mfma_f32_32x32x16_bf16 v[48:63], v[192:195], v[212:215], v[48:63]
    s_waitcnt lgkmcnt(7)
    v_mfma_f32_32x32x16_bf16 v[32:47], v[196:199], v[216:219], v[32:47]
    s_waitcnt lgkmcnt(6)
    v_mfma_f32_32x32x16_bf16 v[48:63], v[196:199], v[220:223], v[48:63]
    s_waitcnt lgkmcnt(0)
    v_mfma_f32_32x32x16_bf16 v[32:47], v[200:203], v[224:227], v[32:47]
    v_mfma_f32_32x32x16_bf16 v[48:63], v[200:203], v[228:231], v[48:63]
    v_mfma_f32_32x32x16_bf16 v[32:47], v[204:207], v[232:235], v[32:47]
    v_mfma_f32_32x32x16_bf16 v[48:63], v[204:207], v[236:239], v[48:63]
    v_mov_b32 v77, s43
    v_mov_b32 v79, s43
    s_nop 9
    v_fma_f32 v114, v80, v32, v33
    v_fma_f32 v115, v80, v48, v49
    v_fma_f32 v114, -v81, v48, v114
    v_fma_f32 v115, v81, v32, v115
    v_fma_f32 v112, v80, v114, v34
    v_fma_f32 v113, v80, v115, v50
    v_fma_f32 v112, -v81, v115, v112
    v_fma_f32 v113, v81, v114, v113
    s_setprio 1
    s_add_u32 m0, s83, 24576
    s_bfe_u32 s73, s87, 196620
    s_mul_i32 s73, s73, 176128
    buffer_load_dwordx4 v104, s[56:59], s73 offen offset:0  lds
    s_setprio 3
    v_fma_f32 v114, v80, v112, v35
    v_fma_f32 v115, v80, v113, v51
    v_fma_f32 v114, -v81, v113, v114
    v_fma_f32 v115, v81, v112, v115
    v_fma_f32 v112, v80, v114, v36
    v_fma_f32 v113, v80, v115, v52
    v_fma_f32 v112, -v81, v115, v112
    v_fma_f32 v113, v81, v114, v113
    s_setprio 1
    buffer_load_dwordx4 v105, s[56:59], s73 offen offset:1024  lds
    s_setprio 3
    v_fma_f32 v114, v80, v112, v37
    v_fma_f32 v115, v80, v113, v53
    v_fma_f32 v114, -v81, v113, v114
    v_fma_f32 v115, v81, v112, v115
    v_fma_f32 v112, v80, v114, v38
    v_fma_f32 v113, v80, v115, v54
    v_fma_f32 v112, -v81, v115, v112
    v_fma_f32 v113, v81, v114, v113
    s_setprio 1
    buffer_load_dwordx4 v106, s[56:59], s73 offen offset:2048  lds
    s_setprio 3
    v_fma_f32 v114, v80, v112, v39
    v_fma_f32 v115, v80, v113, v55
    v_fma_f32 v114, -v81, v113, v114
    v_fma_f32 v115, v81, v112, v115
    v_fma_f32 v112, v80, v114, v40
    v_fma_f32 v113, v80, v115, v56
    v_fma_f32 v112, -v81, v115, v112
    v_fma_f32 v113, v81, v114, v113
    s_setprio 1
    s_add_u32 m0, s83, 36864
    s_nop 0
    buffer_load_dwordx4 v104, s[60:63], s73 offen offset:0  lds
    s_setprio 3
    v_fma_f32 v114, v80, v112, v41
    v_fma_f32 v115, v80, v113, v57
    v_fma_f32 v114, -v81, v113, v114
    v_fma_f32 v115, v81, v112, v115
    v_fma_f32 v112, v80, v114, v42
    v_fma_f32 v113, v80, v115, v58
    v_fma_f32 v112, -v81, v115, v112
    v_fma_f32 v113, v81, v114, v113
    s_setprio 1
    buffer_load_dwordx4 v105, s[60:63], s73 offen offset:1024  lds
    s_setprio 3
    v_fma_f32 v114, v80, v112, v43
    v_fma_f32 v115, v80, v113, v59
    v_fma_f32 v114, -v81, v113, v114
    v_fma_f32 v115, v81, v112, v115
    v_fma_f32 v112, v80, v114, v44
    v_fma_f32 v113, v80, v115, v60
    v_fma_f32 v112, -v81, v115, v112
    v_fma_f32 v113, v81, v114, v113
    s_setprio 1
    buffer_load_dwordx4 v106, s[60:63], s73 offen offset:2048  lds
    s_setprio 3
    v_fma_f32 v114, v80, v112, v45
    v_fma_f32 v115, v80, v113, v61
    v_fma_f32 v114, -v81, v113, v114
    v_fma_f32 v115, v81, v112, v115
    v_fma_f32 v112, v80, v114, v46
    v_fma_f32 v113, v80, v115, v62
    v_fma_f32 v112, -v81, v115, v112
    v_fma_f32 v113, v81, v114, v113
    s_setprio 1
    s_add_u32 m0, s26, 16
    s_mov_b64 exec, 1
    buffer_load_dword off, s[28:31], 12 lds
    s_mov_b64 exec, -1
    s_setprio 3
    v_fma_f32 v114, v80, v112, v47
    v_fma_f32 v115, v80, v113, v63
    v_fma_f32 v114, -v81, v113, v114
    v_fma_f32 v115, v81, v112, v115
    v_mov_b32 v116, v114
    v_mov_b32 v117, v115
    s_nop 1
    v_permlane32_swap_b32 v114, v116
    v_permlane32_swap_b32 v115, v117
    v_fma_f32 v118, v82, v114, v116
    v_fma_f32 v119, v82, v115, v117
    v_fma_f32 v118, -v83, v115, v118
    v_fma_f32 v119, v83, v114, v119
    s_setprio 1
    buffer_load_dword v9, v8, s[16:19], 0 offen
    s_setprio 3
    ds_write_b64 v110, v[118:119]
    v_mov_b32 v17, 1
    ds_write_b32 v15, v17 offset:16
L_ex:
    ds_read_b32 v17, v16 offset:32
    s_waitcnt lgkmcnt(0)
    v_cmp_gt_u32 vcc, 1, v17
    s_cbranch_vccnz L_ex
    ds_read_b64 v[64:65], v109 offset:0
    ds_read_b64 v[66:67], v109 offset:512
    ds_read_b64 v[68:69], v109 offset:1024
    ds_read_b64 v[70:71], v109 offset:1536
    s_waitcnt lgkmcnt(0)
    v_fma_f32 v72, v84, v64, v66
    v_fma_f32 v73, v84, v65, v67
    v_fma_f32 v72, -v85, v65, v72
    v_fma_f32 v73, v85, v64, v73
    v_fma_f32 v74, v84, v72, v68
    v_fma_f32 v75, v84, v73, v69
    v_fma_f32 v74, -v85, v73, v74
    v_fma_f32 v75, v85, v72, v75
    v_fma_f32 v76, v84, v74, v70
    v_fma_f32 v78, v84, v75, v71
    v_fma_f32 v76, -v85, v75, v76
    v_fma_f32 v78, v85, v74, v78
    s_mov_b32 exec_hi, 0
    buffer_store_dwordx4 v[76:79], v111, s[44:47], 0 offen sc1
    s_mov_b64 exec, -1
L_pa1:
    ds_read_b32 v17, v16 offset:0
    s_waitcnt lgkmcnt(0)
    v_cmp_gt_u32 vcc, 1, v17
    s_cbranch_vccnz L_pa1
    v_mov_b32 v122, 0
    v_mov_b32 v123, 0
    s_cmp_eq_u32 s42, 1
    s_cselect_b64 vcc, -1, 0
    v_cndmask_b32 v122, v122, v64, vcc
    v_cndmask_b32 v123, v123, v65, vcc
    s_cmp_eq_u32 s42, 2
    s_cselect_b64 vcc, -1, 0
    v_cndmask_b32 v122, v122, v72, vcc
    v_cndmask_b32 v123, v123, v73, vcc
    s_cmp_eq_u32 s42, 3
    s_cselect_b64 vcc, -1, 0
    v_cndmask_b32 v122, v122, v74, vcc
    v_cndmask_b32 v123, v123, v75, vcc
    v_fma_f32 v88, v82, v122, v114
    v_fma_f32 v89, v82, v123, v115
    v_fma_f32 v88, -v83, v123, v88
    v_fma_f32 v89, v83, v122, v89
    s_setprio 1
    s_add_u32 m0, s83, 49152
    s_bfe_u32 s73, s87, 196624
    s_mul_i32 s73, s73, 176128
    buffer_load_dwordx4 v104, s[56:59], s73 offen offset:0  lds
    s_setprio 3
    s_mov_b32 vcc_lo, -1
    s_mov_b32 vcc_hi, 0
    v_cndmask_b32 v88, v88, v122, vcc
    v_cndmask_b32 v89, v89, v123, vcc
    v_mul_f32 v112, v87, v48
    v_mul_f32 v48, v86, v48
    v_fmac_f32 v48, v87, v32
    v_fma_f32 v32, v86, v32, -v112
    v_mul_f32 v113, v87, v49
    v_mul_f32 v49, v86, v49
    v_fmac_f32 v49, v87, v33
    v_fma_f32 v33, v86, v33, -v113
    s_setprio 1
    buffer_load_dwordx4 v105, s[56:59], s73 offen offset:1024  lds
    s_setprio 3
    v_mul_f32 v112, v87, v50
    v_mul_f32 v50, v86, v50
    v_fmac_f32 v50, v87, v34
    v_fma_f32 v34, v86, v34, -v112
    v_mul_f32 v113, v87, v51
    v_mul_f32 v51, v86, v51
    v_fmac_f32 v51, v87, v35
    v_fma_f32 v35, v86, v35, -v113
    s_setprio 1
    buffer_load_dwordx4 v106, s[56:59], s73 offen offset:2048  lds
    s_setprio 3
    v_mul_f32 v112, v87, v52
    v_mul_f32 v52, v86, v52
    v_fmac_f32 v52, v87, v36
    v_fma_f32 v36, v86, v36, -v112
    v_mul_f32 v113, v87, v53
    v_mul_f32 v53, v86, v53
    v_fmac_f32 v53, v87, v37
    v_fma_f32 v37, v86, v37, -v113
    s_setprio 1
    s_add_u32 m0, s83, 61440
    s_nop 0
    buffer_load_dwordx4 v104, s[60:63], s73 offen offset:0  lds
    s_setprio 3
    v_mul_f32 v112, v87, v54
    v_mul_f32 v54, v86, v54
    v_fmac_f32 v54, v87, v38
    v_fma_f32 v38, v86, v38, -v112
    v_mul_f32 v113, v87, v55
    v_mul_f32 v55, v86, v55
    v_fmac_f32 v55, v87, v39
    v_fma_f32 v39, v86, v39, -v113
    s_setprio 1
    buffer_load_dwordx4 v105, s[60:63], s73 offen offset:1024  lds
    s_setprio 3
    v_mul_f32 v112, v87, v56
    v_mul_f32 v56, v86, v56
    v_fmac_f32 v56, v87, v40
    v_fma_f32 v40, v86, v40, -v112
    v_mul_f32 v113, v87, v57
    v_mul_f32 v57, v86, v57
    v_fmac_f32 v57, v87, v41
    v_fma_f32 v41, v86, v41, -v113
    s_setprio 1
    buffer_load_dwordx4 v106, s[60:63], s73 offen offset:2048  lds
    s_setprio 3
    v_mul_f32 v112, v87, v58
    v_mul_f32 v58, v86, v58
    v_fmac_f32 v58, v87, v42
    v_fma_f32 v42, v86, v42, -v112
    v_mul_f32 v113, v87, v59
    v_mul_f32 v59, v86, v59
    v_fmac_f32 v59, v87, v43
    v_fma_f32 v43, v86, v43, -v113
    s_setprio 1
    s_add_u32 m0, s26, 16
    s_mov_b64 exec, 1
    buffer_load_dword off, s[28:31], 16 lds
    s_mov_b64 exec, -1
    s_setprio 3
    v_mul_f32 v112, v87, v60
    v_mul_f32 v60, v86, v60
    v_fmac_f32 v60, v87, v44
    v_fma_f32 v44, v86, v44, -v112
    v_mul_f32 v113, v87, v61
    v_mul_f32 v61, v86, v61
    v_fmac_f32 v61, v87, v45
    v_fma_f32 v45, v86, v45, -v113
    s_setprio 1
    s_add_u32 m0, s22, 147456
    s_mov_b32 s72, 15360
    buffer_load_dwordx4 v10, s[48:51], 0 offen lds
    s_setprio 3
    v_mul_f32 v112, v87, v62
    v_mul_f32 v62, v86, v62
    v_fmac_f32 v62, v87, v46
    v_fma_f32 v46, v86, v46, -v112
    v_mul_f32 v113, v87, v63
    v_mul_f32 v63, v86, v63
    v_fmac_f32 v63, v87, v47
    v_fma_f32 v47, v86, v47, -v113
    s_setprio 1
    buffer_load_dwordx4 v10, s[48:51], s72 offen offset:1024 lds
    s_setprio 3
    buffer_load_dwordx4 v[64:67], v107, s[44:47], 0 offen sc1
    buffer_load_dwordx4 v[68:71], v108, s[44:47], 0 offen sc1
    s_setprio 1
    s_add_u32 m0, s83, 73728
    s_bfe_u32 s73, s87, 196628
    s_mul_i32 s73, s73, 176128
    buffer_load_dwordx4 v104, s[56:59], s73 offen offset:0  lds
    buffer_load_dwordx4 v105, s[56:59], s73 offen offset:1024  lds
    buffer_load_dwordx4 v106, s[56:59], s73 offen offset:2048  lds
    s_add_u32 m0, s83, 86016
    s_nop 0
    buffer_load_dwordx4 v104, s[60:63], s73 offen offset:0  lds
    buffer_load_dwordx4 v105, s[60:63], s73 offen offset:1024  lds
    buffer_load_dwordx4 v106, s[60:63], s73 offen offset:2048  lds
    s_add_u32 m0, s26, 16
    s_mov_b64 exec, 1
    buffer_load_dword off, s[28:31], 20 lds
    s_mov_b64 exec, -1
    s_setprio 3
    s_lshl_b32 s81, s42, 7
    s_add_u32 s81, s81, 157952
    v_and_b32 v124, 31, v0
    v_lshl_add_u32 v124, v124, 2, s81
    ds_read_b32 v124, v124
    s_waitcnt lgkmcnt(0)
    v_mul_f32 v124, 3216550459, v124
    v_exp_f32 v124, v124
    s_nop 0
    v_add_f32 v124, 1.0, v124
    v_rcp_f32 v124, v124
    s_nop 0
    v_cvt_pk_bf16_f32 v124, v124, v124
    v_and_b32 v96, v124, v96
    v_and_b32 v97, v124, v97
    v_and_b32 v98, v124, v98
    v_and_b32 v99, v124, v99
    v_and_b32 v100, v124, v100
    v_and_b32 v101, v124, v101
    v_and_b32 v102, v124, v102
    v_and_b32 v103, v124, v103
    s_waitcnt vmcnt(7)
    s_mov_b32 s88, 32768
L_agg_chk:
    v_cmp_eq_u32 s[84:85], s43, v65
    v_cmp_eq_u32 s[8:9], s43, v67
    v_cmp_eq_u32 vcc, 1073741824, v107
    s_and_b64 s[84:85], s[84:85], s[8:9]
    s_or_b64 s[84:85], s[84:85], vcc
    s_mov_b64 s[0:1], s[84:85]
    v_cmp_eq_u32 s[84:85], s43, v69
    v_cmp_eq_u32 s[8:9], s43, v71
    v_cmp_eq_u32 vcc, 1073741824, v108
    s_and_b64 s[84:85], s[84:85], s[8:9]
    s_or_b64 s[84:85], s[84:85], vcc
    s_and_b64 s[84:85], s[84:85], s[0:1]
    s_cmp_eq_u64 s[84:85], -1
    s_cbranch_scc1 L_agg_ok
    s_sub_u32 s88, s88, 1
    s_cmp_eq_u32 s88, 0
    s_cbranch_scc1 L_agg_ok
    buffer_load_dwordx4 v[64:67], v107, s[44:47], 0 offen sc1
    buffer_load_dwordx4 v[68:71], v108, s[44:47], 0 offen sc1
    s_waitcnt vmcnt(0)
    s_branch L_agg_chk
L_agg_ok:
    v_mul_f32 v112, v90, v64
    v_mul_f32 v113, v90, v66
    v_fma_f32 v112, -v91, v66, v112
    v_fmac_f32 v113, v91, v64
    v_fma_f32 v112, v92, v68, v112
    v_fma_f32 v113, v92, v70, v113
    v_fma_f32 v112, -v93, v70, v112
    v_fma_f32 v113, v93, v68, v113
    v_mov_b32 v114, v112
    v_mov_b32 v115, v113
    s_nop 1
    v_permlane32_swap_b32 v112, v114
    v_permlane32_swap_b32 v113, v115
    v_add_f32 v112, v112, v114
    v_add_f32 v113, v113, v115
    ds_write_b64 v110, v[112:113] offset:6144
    v_mov_b32 v17, 2
    ds_write_b32 v15, v17 offset:16
L_pa2:
    ds_read_b32 v17, v16 offset:0
    s_waitcnt lgkmcnt(0)
    v_cmp_gt_u32 vcc, 2, v17
    s_cbranch_vccnz L_pa2
    s_setprio 1
    s_add_u32 m0, s83, 98304
    s_bfe_u32 s73, s87, 196632
    s_mul_i32 s73, s73, 176128
    buffer_load_dwordx4 v104, s[56:59], s73 offen offset:0  lds
    buffer_load_dwordx4 v105, s[56:59], s73 offen offset:1024  lds
    buffer_load_dwordx4 v106, s[56:59], s73 offen offset:2048  lds
    s_add_u32 m0, s83, 110592
    s_nop 0
    buffer_load_dwordx4 v104, s[60:63], s73 offen offset:0  lds
    buffer_load_dwordx4 v105, s[60:63], s73 offen offset:1024  lds
    buffer_load_dwordx4 v106, s[60:63], s73 offen offset:2048  lds
    s_add_u32 m0, s26, 16
    s_mov_b64 exec, 1
    buffer_load_dword off, s[28:31], 24 lds
    s_mov_b64 exec, -1
    s_setprio 3
L_ex2:
    ds_read_b32 v17, v16 offset:32
    s_waitcnt lgkmcnt(0)
    v_cmp_gt_u32 vcc, 2, v17
    s_cbranch_vccnz L_ex2
    ds_read_b64 v[64:65], v109 offset:6144
    ds_read_b64 v[66:67], v109 offset:6656
    ds_read_b64 v[68:69], v109 offset:7168
    ds_read_b64 v[70:71], v109 offset:7680
    s_waitcnt lgkmcnt(0)
    v_add_f32 v64, v64, v66
    v_add_f32 v68, v68, v70
    v_add_f32 v65, v65, v67
    v_add_f32 v69, v69, v71
    v_add_f32 v64, v64, v68
    v_add_f32 v65, v65, v69
    v_fma_f32 v88, v94, v64, v88
    v_fma_f32 v89, v94, v65, v89
    v_fma_f32 v88, -v95, v65, v88
    v_fma_f32 v89, v95, v64, v89
    v_mul_f32 v112, v86, v88
    v_mul_f32 v113, v86, v89
    v_fma_f32 v112, -v87, v89, v112
    v_fmac_f32 v113, v87, v88
L_pa3:
    ds_read_b32 v17, v16 offset:0
    s_waitcnt lgkmcnt(0)
    v_cmp_gt_u32 vcc, 3, v17
    s_cbranch_vccnz L_pa3
    s_load_dword s13, s[4:5], 0 glc
    s_load_dword s13, s[4:5], 256 glc
    s_load_dword s13, s[4:5], 512 glc
    s_load_dword s13, s[4:5], 768 glc
    v_fma_f32 v32, v80, v112, v32
    v_fma_f32 v48, v80, v113, v48
    v_fma_f32 v32, -v81, v113, v32
    v_fma_f32 v48, v81, v112, v48
    s_setprio 1
    s_add_u32 m0, s83, 122880
    s_bfe_u32 s73, s87, 196636
    s_mul_i32 s73, s73, 176128
    buffer_load_dwordx4 v104, s[56:59], s73 offen offset:0  lds
    s_setprio 3
    v_fma_f32 v33, v80, v32, v33
    v_fma_f32 v49, v80, v48, v49
    v_fma_f32 v33, -v81, v48, v33
    v_fma_f32 v49, v81, v32, v49
    v_cvt_pk_bf16_f32 v64, v32, v33
    v_cvt_pk_bf16_f32 v72, -v48, -v49
    v_fma_f32 v34, v80, v33, v34
    v_fma_f32 v50, v80, v49, v50
    v_fma_f32 v34, -v81, v49, v34
    v_fma_f32 v50, v81, v33, v50
    s_setprio 1
    buffer_load_dwordx4 v105, s[56:59], s73 offen offset:1024  lds
    s_setprio 3
    v_fma_f32 v35, v80, v34, v35
    v_fma_f32 v51, v80, v50, v51
    v_fma_f32 v35, -v81, v50, v35
    v_fma_f32 v51, v81, v34, v51
    v_cvt_pk_bf16_f32 v65, v34, v35
    v_cvt_pk_bf16_f32 v73, -v50, -v51
    v_fma_f32 v36, v80, v35, v36
    v_fma_f32 v52, v80, v51, v52
    v_fma_f32 v36, -v81, v51, v36
    v_fma_f32 v52, v81, v35, v52
    s_setprio 1
    buffer_load_dwordx4 v106, s[56:59], s73 offen offset:2048  lds
    s_setprio 3
    v_fma_f32 v37, v80, v36, v37
    v_fma_f32 v53, v80, v52, v53
    v_fma_f32 v37, -v81, v52, v37
    v_fma_f32 v53, v81, v36, v53
    v_cvt_pk_bf16_f32 v66, v36, v37
    v_cvt_pk_bf16_f32 v74, -v52, -v53
    v_fma_f32 v38, v80, v37, v38
    v_fma_f32 v54, v80, v53, v54
    v_fma_f32 v38, -v81, v53, v38
    v_fma_f32 v54, v81, v37, v54
    s_setprio 1
    s_add_u32 m0, s83, 135168
    s_nop 0
    buffer_load_dwordx4 v104, s[60:63], s73 offen offset:0  lds
    s_setprio 3
    v_fma_f32 v39, v80, v38, v39
    v_fma_f32 v55, v80, v54, v55
    v_fma_f32 v39, -v81, v54, v39
    v_fma_f32 v55, v81, v38, v55
    v_cvt_pk_bf16_f32 v67, v38, v39
    v_cvt_pk_bf16_f32 v75, -v54, -v55
    v_fma_f32 v40, v80, v39, v40
    v_fma_f32 v56, v80, v55, v56
    v_fma_f32 v40, -v81, v55, v40
    v_fma_f32 v56, v81, v39, v56
    s_setprio 1
    buffer_load_dwordx4 v105, s[60:63], s73 offen offset:1024  lds
    s_setprio 3
    v_fma_f32 v41, v80, v40, v41
    v_fma_f32 v57, v80, v56, v57
    v_fma_f32 v41, -v81, v56, v41
    v_fma_f32 v57, v81, v40, v57
    v_cvt_pk_bf16_f32 v68, v40, v41
    v_cvt_pk_bf16_f32 v76, -v56, -v57
    v_fma_f32 v42, v80, v41, v42
    v_fma_f32 v58, v80, v57, v58
    v_fma_f32 v42, -v81, v57, v42
    v_fma_f32 v58, v81, v41, v58
    s_setprio 1
    buffer_load_dwordx4 v106, s[60:63], s73 offen offset:2048  lds
    s_setprio 3
    v_fma_f32 v43, v80, v42, v43
    v_fma_f32 v59, v80, v58, v59
    v_fma_f32 v43, -v81, v58, v43
    v_fma_f32 v59, v81, v42, v59
    v_cvt_pk_bf16_f32 v69, v42, v43
    v_cvt_pk_bf16_f32 v77, -v58, -v59
    v_fma_f32 v44, v80, v43, v44
    v_fma_f32 v60, v80, v59, v60
    v_fma_f32 v44, -v81, v59, v44
    v_fma_f32 v60, v81, v43, v60
    s_setprio 1
    s_add_u32 m0, s26, 16
    s_mov_b64 exec, 1
    buffer_load_dword off, s[28:31], 28 lds
    s_mov_b64 exec, -1
    s_setprio 3
    v_fma_f32 v45, v80, v44, v45
    v_fma_f32 v61, v80, v60, v61
    v_fma_f32 v45, -v81, v60, v45
    v_fma_f32 v61, v81, v44, v61
    v_cvt_pk_bf16_f32 v70, v44, v45
    v_cvt_pk_bf16_f32 v78, -v60, -v61
    v_fma_f32 v46, v80, v45, v46
    v_fma_f32 v62, v80, v61, v62
    v_fma_f32 v46, -v81, v61, v46
    v_fma_f32 v62, v81, v45, v62
    v_fma_f32 v47, v80, v46, v47
    v_fma_f32 v63, v80, v62, v63
    v_fma_f32 v47, -v81, v62, v47
    v_fma_f32 v63, v81, v46, v63
    v_cvt_pk_bf16_f32 v71, v46, v47
    v_cvt_pk_bf16_f32 v79, -v62, -v63
    v_mfma_f32_32x32x16_bf16 v[32:47], v[64:67], v[96:99], 0
    v_mfma_f32_32x32x16_bf16 v[48:63], v[72:75], v[96:99], 0
    v_mfma_f32_32x32x16_bf16 v[32:47], v[68:71], v[100:103], v[32:47]
    v_mfma_f32_32x32x16_bf16 v[48:63], v[76:79], v[100:103], v[48:63]
    s_nop 10
    v_cvt_pk_bf16_f32 v64, v32, v33
    v_cvt_pk_bf16_f32 v65, v34, v35
    v_cvt_pk_bf16_f32 v66, v36, v37
    v_cvt_pk_bf16_f32 v67, v38, v39
    buffer_store_dwordx4 v[64:67], v7, s[44:47], 0 offen offset:0 sc1
    v_cvt_pk_bf16_f32 v68, v40, v41
    v_cvt_pk_bf16_f32 v69, v42, v43
    v_cvt_pk_bf16_f32 v70, v44, v45
    v_cvt_pk_bf16_f32 v71, v46, v47
    buffer_store_dwordx4 v[68:71], v7, s[44:47], 0 offen offset:1024 sc1
    v_cvt_pk_bf16_f32 v72, v48, v49
    v_cvt_pk_bf16_f32 v73, v50, v51
    v_cvt_pk_bf16_f32 v74, v52, v53
    v_cvt_pk_bf16_f32 v75, v54, v55
    buffer_store_dwordx4 v[72:75], v7, s[44:47], s75 offen offset:0 sc1
    v_cvt_pk_bf16_f32 v76, v56, v57
    v_cvt_pk_bf16_f32 v77, v58, v59
    v_cvt_pk_bf16_f32 v78, v60, v61
    v_cvt_pk_bf16_f32 v79, v62, v63
    buffer_store_dwordx4 v[76:79], v7, s[44:47], s75 offen offset:1024 sc1
L_pa4:
    ds_read_b32 v17, v16 offset:0
    s_waitcnt lgkmcnt(0)
    v_cmp_gt_u32 vcc, 4, v17
    s_cbranch_vccnz L_pa4
    s_setprio 1
    s_add_u32 m0, s82, 0
    s_mov_b32 s72, 0
    buffer_load_dwordx4 v1, s[52:55], s72 offen offset:0 lds
    buffer_load_dwordx4 v2, s[52:55], s72 offen offset:1024 lds
    buffer_load_dwordx4 v3, s[52:55], s72 offen offset:2048 lds
    buffer_load_dwordx4 v4, s[52:55], s72 offen offset:3072 lds
    s_setprio 3
L_pa5:
    ds_read_b32 v17, v16 offset:0
    s_waitcnt lgkmcnt(0)
    v_cmp_gt_u32 vcc, 5, v17
    s_cbranch_vccnz L_pa5
    s_setprio 1
    s_add_u32 m0, s82, 16384
    s_mov_b32 s72, 0
    buffer_load_dwordx4 v1, s[64:67], s72 offen offset:0 lds
    buffer_load_dwordx4 v2, s[64:67], s72 offen offset:1024 lds
    buffer_load_dwordx4 v3, s[64:67], s72 offen offset:2048 lds
    buffer_load_dwordx4 v4, s[64:67], s72 offen offset:3072 lds
    s_setprio 3
    ds_read_u16 v216, v13 offset:0
    ds_read_u16 v217, v13 offset:64
    ds_read_u16 v218, v13 offset:128
    ds_read_u16 v219, v13 offset:192
    ds_read_u16 v224, v13 offset:512
    ds_read_u16 v225, v13 offset:576
    ds_read_u16 v226, v13 offset:640
    ds_read_u16 v227, v13 offset:704
    ds_read_u16 v220, v13 offset:32
    ds_read_u16 v221, v13 offset:96
    ds_read_u16 v222, v13 offset:160
    ds_read_u16 v223, v13 offset:224
    s_waitcnt lgkmcnt(8)
    ds_read_u16 v228, v13 offset:544
    ds_read_u16 v229, v13 offset:608
    ds_read_u16 v230, v13 offset:672
    ds_read_u16 v231, v13 offset:736
    s_waitcnt lgkmcnt(8)
    v_mov_b32 v114, s43
    v_lshlrev_b32 v115, 2, v0
    s_waitcnt vmcnt(8)
    s_mov_b32 exec_hi, 0
    buffer_store_dword v114, v115, s[44:47], s35 offen sc1
    s_mov_b64 exec, -1
    s_setprio 1
    s_add_u32 m0, s82, 32768
    s_mov_b32 s72, 128
    buffer_load_dwordx4 v1, s[52:55], s72 offen offset:0 lds
    buffer_load_dwordx4 v2, s[52:55], s72 offen offset:1024 lds
    buffer_load_dwordx4 v3, s[52:55], s72 offen offset:2048 lds
    buffer_load_dwordx4 v4, s[52:55], s72 offen offset:3072 lds
    s_setprio 3
L_pa6:
    ds_read_b32 v17, v16 offset:0
    s_waitcnt lgkmcnt(0)
    v_cmp_gt_u32 vcc, 6, v17
    s_cbranch_vccnz L_pa6
    s_setprio 1
    s_add_u32 m0, s82, 49152
    s_mov_b32 s72, 128
    buffer_load_dwordx4 v1, s[64:67], s72 offen offset:0 lds
    buffer_load_dwordx4 v2, s[64:67], s72 offen offset:1024 lds
    buffer_load_dwordx4 v3, s[64:67], s72 offen offset:2048 lds
    buffer_load_dwordx4 v4, s[64:67], s72 offen offset:3072 lds
    s_setprio 3
    s_setprio 1
    s_add_u32 m0, s26, 16
    s_mov_b64 exec, 1
    buffer_load_dword off, s[28:31], 32 lds
    s_mov_b64 exec, -1
    s_setprio 3
    s_setprio 1
    s_add_u32 s73, s12, 0
    s_sub_u32 s3, s73, 11
    s_cselect_b32 s73, s73, s3
    s_lshl_b32 s73, s73, 15
    s_add_u32 m0, s22, 147456
    s_nop 0
    buffer_load_dwordx4 v5, s[68:71], s73 offen lds
    s_add_u32 m0, s22, 148480
    s_nop 0
    buffer_load_dwordx4 v6, s[68:71], s73 offen lds
    s_setprio 3
    s_setprio 1
    s_add_u32 s73, s12, 1
    s_sub_u32 s3, s73, 11
    s_cselect_b32 s73, s73, s3
    s_lshl_b32 s73, s73, 15
    s_add_u32 m0, s22, 65536
    s_nop 0
    buffer_load_dwordx4 v5, s[68:71], s73 offen lds
    s_add_u32 m0, s22, 66560
    s_nop 0
    buffer_load_dwordx4 v6, s[68:71], s73 offen lds
    s_setprio 3
    ds_read_b128 v[232:235], v20 offset:0
    ds_read_b128 v[236:239], v20 offset:64
    s_waitcnt lgkmcnt(0)
    v_mul_f32 v232, 3216550459, v232
    v_mul_f32 v233, 3216550459, v233
    v_mul_f32 v234, 3216550459, v234
    v_mul_f32 v235, 3216550459, v235
    v_mul_f32 v236, 3216550459, v236
    v_mul_f32 v237, 3216550459, v237
    v_mul_f32 v238, 3216550459, v238
    v_mul_f32 v239, 3216550459, v239
    v_exp_f32 v232, v232
    v_exp_f32 v233, v233
    v_exp_f32 v234, v234
    v_exp_f32 v235, v235
    v_exp_f32 v236, v236
    v_exp_f32 v237, v237
    v_exp_f32 v238, v238
    v_exp_f32 v239, v239
    v_add_f32 v232, 1.0, v232
    v_add_f32 v233, 1.0, v233
    v_add_f32 v234, 1.0, v234
    v_add_f32 v235, 1.0, v235
    v_add_f32 v236, 1.0, v236
    v_add_f32 v237, 1.0, v237
    v_add_f32 v238, 1.0, v238
    v_add_f32 v239, 1.0, v239
    v_rcp_f32 v232, v232
    v_rcp_f32 v233, v233
    v_rcp_f32 v234, v234
    v_rcp_f32 v235, v235
    v_rcp_f32 v236, v236
    v_rcp_f32 v237, v237
    v_rcp_f32 v238, v238
    v_rcp_f32 v239, v239
    s_load_dword s56, s[4:5], 0 glc
    s_load_dword s57, s[4:5], 256 glc
    s_load_dword s58, s[4:5], 512 glc
    s_load_dword s59, s[4:5], 768 glc
    v_lshlrev_b32 v28, 16, v28
    v_lshlrev_b32 v29, 16, v29
    v_lshlrev_b32 v216, 16, v216
    v_mul_f32 v216, v216, v28
    v_mul_f32 v216, v216, v232
    v_lshlrev_b32 v217, 16, v217
    v_mul_f32 v217, v217, v28
    v_mul_f32 v217, v217, v233
    v_lshlrev_b32 v218, 16, v218
    v_mul_f32 v218, v218, v28
    v_mul_f32 v218, v218, v234
    v_lshlrev_b32 v219, 16, v219
    v_mul_f32 v219, v219, v28
    v_mul_f32 v219, v219, v235
    v_lshlrev_b32 v220, 16, v220
    v_mul_f32 v220, v220, v29
    v_mul_f32 v220, v220, v232
    v_lshlrev_b32 v221, 16, v221
    v_mul_f32 v221, v221, v29
    v_mul_f32 v221, v221, v233
    v_lshlrev_b32 v222, 16, v222
    v_mul_f32 v222, v222, v29
    v_mul_f32 v222, v222, v234
    v_lshlrev_b32 v223, 16, v223
    v_mul_f32 v223, v223, v29
    v_mul_f32 v223, v223, v235
    v_lshlrev_b32 v224, 16, v224
    v_mul_f32 v224, v224, v28
    v_mul_f32 v224, v224, v236
    v_lshlrev_b32 v225, 16, v225
    v_mul_f32 v225, v225, v28
    v_mul_f32 v225, v225, v237
    v_lshlrev_b32 v226, 16, v226
    v_mul_f32 v226, v226, v28
    v_mul_f32 v226, v226, v238
    v_lshlrev_b32 v227, 16, v227
    v_mul_f32 v227, v227, v28
    v_mul_f32 v227, v227, v239
    v_lshlrev_b32 v228, 16, v228
    v_mul_f32 v228, v228, v29
    v_mul_f32 v228, v228, v236
    v_lshlrev_b32 v229, 16, v229
    v_mul_f32 v229, v229, v29
    v_mul_f32 v229, v229, v237
    v_lshlrev_b32 v230, 16, v230
    v_mul_f32 v230, v230, v29
    v_mul_f32 v230, v230, v238
    v_lshlrev_b32 v231, 16, v231
    v_mul_f32 v231, v231, v29
    v_mul_f32 v231, v231, v239
L_pa7:
    ds_read_b32 v17, v16 offset:0
    s_waitcnt lgkmcnt(0)
    v_cmp_gt_u32 vcc, 7, v17
    s_cbranch_vccnz L_pa7
    s_setprio 1
    s_add_u32 s73, s12, 2
    s_sub_u32 s3, s73, 11
    s_cselect_b32 s73, s73, s3
    s_lshl_b32 s73, s73, 15
    s_add_u32 m0, s22, 73728
    s_nop 0
    buffer_load_dwordx4 v5, s[68:71], s73 offen lds
    s_add_u32 m0, s22, 74752
    s_nop 0
    buffer_load_dwordx4 v6, s[68:71], s73 offen lds
    s_setprio 3
    s_setprio 1
    s_add_u32 s73, s12, 3
    s_sub_u32 s3, s73, 11
    s_cselect_b32 s73, s73, s3
    s_lshl_b32 s73, s73, 15
    s_add_u32 m0, s22, 81920
    s_nop 0
    buffer_load_dwordx4 v5, s[68:71], s73 offen lds
    s_add_u32 m0, s22, 82944
    s_nop 0
    buffer_load_dwordx4 v6, s[68:71], s73 offen lds
    s_setprio 3
    s_setprio 1
    s_add_u32 s73, s12, 4
    s_sub_u32 s3, s73, 11
    s_cselect_b32 s73, s73, s3
    s_lshl_b32 s73, s73, 15
    s_add_u32 m0, s22, 90112
    s_nop 0
    buffer_load_dwordx4 v5, s[68:71], s73 offen lds
    s_add_u32 m0, s22, 91136
    s_nop 0
    buffer_load_dwordx4 v6, s[68:71], s73 offen lds
    s_add_u32 m0, s26, 16
    s_mov_b64 exec, 1
    buffer_load_dword off, s[28:31], 36 lds
    s_mov_b64 exec, -1
    s_setprio 3
    s_mov_b32 s88, 32768
    s_branch L_hs_wait
L_hs_try:
    s_load_dword s56, s[4:5], 0 glc
    s_load_dword s57, s[4:5], 256 glc
    s_load_dword s58, s[4:5], 512 glc
    s_load_dword s59, s[4:5], 768 glc
L_hs_wait:
    s_waitcnt lgkmcnt(0)
    s_xor_b32 s56, s56, s43
    s_xor_b32 s57, s57, s43
    s_or_b32 s56, s56, s57
    s_xor_b32 s58, s58, s43
    s_or_b32 s56, s56, s58
    s_xor_b32 s59, s59, s43
    s_or_b32 s56, s56, s59
    s_cbranch_scc0 L_hs_ok
    s_sub_u32 s88, s88, 1
    s_cmp_lg_u32 s88, 0
    s_cbranch_scc1 L_hs_try
L_hs_ok:
    buffer_load_dwordx4 v[128:131], v18, s[44:47], 0 offen offset:0 sc1
    buffer_load_dwordx4 v[132:135], v18, s[44:47], 0 offen offset:2048 sc1
    buffer_load_dwordx4 v[136:139], v18, s[44:47], s74 offen offset:0 sc1
    buffer_load_dwordx4 v[140:143], v18, s[44:47], s74 offen offset:2048 sc1
    buffer_load_dwordx4 v[144:147], v18, s[44:47], s75 offen offset:0 sc1
    buffer_load_dwordx4 v[148:151], v18, s[44:47], s75 offen offset:2048 sc1
    buffer_load_dwordx4 v[152:155], v18, s[44:47], s76 offen offset:0 sc1
    buffer_load_dwordx4 v[156:159], v18, s[44:47], s76 offen offset:2048 sc1
    buffer_load_dwordx4 v[160:163], v18, s[44:47], s77 offen offset:0 sc1
    buffer_load_dwordx4 v[164:167], v18, s[44:47], s77 offen offset:2048 sc1
    buffer_load_dwordx4 v[168:171], v18, s[44:47], s78 offen offset:0 sc1
    buffer_load_dwordx4 v[172:175], v18, s[44:47], s78 offen offset:2048 sc1
    buffer_load_dwordx4 v[176:179], v18, s[44:47], s79 offen offset:0 sc1
    buffer_load_dwordx4 v[180:183], v18, s[44:47], s79 offen offset:2048 sc1
    buffer_load_dwordx4 v[184:187], v18, s[44:47], s80 offen offset:0 sc1
    buffer_load_dwordx4 v[188:191], v18, s[44:47], s80 offen offset:2048 sc1
    s_mov_b32 s68, s32
    s_mov_b32 s69, s33
    s_mov_b32 s70, 4194304
    s_mov_b32 s71, 0x20000
    v_subrev_u32 v8, 16, v15
    v_mov_b32 v28, s43
    v_mov_b32 v29, s43
    s_add_u32 s48, s12, 0
    s_sub_u32 s3, s48, 11
    s_cselect_b32 s48, s48, s3
    s_lshl_b32 s48, s48, 12
    s_add_u32 s49, s12, 1
    s_sub_u32 s3, s49, 11
    s_cselect_b32 s49, s49, s3
    s_lshl_b32 s49, s49, 12
    s_add_u32 s50, s12, 2
    s_sub_u32 s3, s50, 11
    s_cselect_b32 s50, s50, s3
    s_lshl_b32 s50, s50, 12
    s_add_u32 s51, s12, 3
    s_sub_u32 s3, s51, 11
    s_cselect_b32 s51, s51, s3
    s_lshl_b32 s51, s51, 12
    s_add_u32 s52, s12, 4
    s_sub_u32 s3, s52, 11
    s_cselect_b32 s52, s52, s3
    s_lshl_b32 s52, s52, 12
    s_add_u32 s53, s12, 5
    s_sub_u32 s3, s53, 11
    s_cselect_b32 s53, s53, s3
    s_lshl_b32 s53, s53, 12
    s_add_u32 s54, s12, 6
    s_sub_u32 s3, s54, 11
    s_cselect_b32 s54, s54, s3
    s_lshl_b32 s54, s54, 12
    s_add_u32 s55, s12, 7
    s_sub_u32 s3, s55, 11
    s_cselect_b32 s55, s55, s3
    s_lshl_b32 s55, s55, 12
    s_add_u32 s56, s12, 8
    s_sub_u32 s3, s56, 11
    s_cselect_b32 s56, s56, s3
    s_lshl_b32 s56, s56, 12
    s_add_u32 s57, s12, 9
    s_sub_u32 s3, s57, 11
    s_cselect_b32 s57, s57, s3
    s_lshl_b32 s57, s57, 12
    s_add_u32 s58, s12, 10
    s_sub_u32 s3, s58, 11
    s_cselect_b32 s58, s58, s3
    s_lshl_b32 s58, s58, 12
L_call:
    ds_read_b32 v17, v16 offset:16
    s_waitcnt lgkmcnt(0)
    v_cmp_gt_u32 vcc, 8, v17
    s_cbranch_vccnz L_call
L_epi:
    ds_read_b32 v17, v8 offset:0
    s_waitcnt lgkmcnt(0)
    v_cmp_gt_u32 vcc, 10, v17
    s_cbranch_vccnz L_epi
    s_setprio 1
    ds_read_b128 v[192:195], v11 offset:0
    ds_read_b128 v[196:199], v11 offset:2048
    ds_read_b128 v[200:203], v11 offset:4096
    ds_read_b128 v[204:207], v11 offset:6144
    ds_read_b128 v[208:211], v11 offset:8192
    s_waitcnt lgkmcnt(3)
    s_waitcnt vmcnt(14)
    v_mfma_f32_16x16x32_bf16 v[32:35], v[128:131], v[192:195], v[216:219]
    ds_read_b128 v[212:215], v11 offset:10240
    v_mfma_f32_16x16x32_bf16 v[40:43], v[132:135], v[192:195], v[224:227]
    v_mfma_f32_16x16x32_bf16 v[36:39], v[128:131], v[196:199], v[220:223]
    ds_read_b128 v[192:195], v11 offset:12288
    v_mfma_f32_16x16x32_bf16 v[44:47], v[132:135], v[196:199], v[228:231]
    s_waitcnt lgkmcnt(3)
    v_mfma_f32_16x16x32_bf16 v[48:51], v[128:131], v[200:203], 0
    ds_read_b128 v[196:199], v11 offset:14336
    v_mfma_f32_16x16x32_bf16 v[56:59], v[132:135], v[200:203], 0
    v_mfma_f32_16x16x32_bf16 v[52:55], v[128:131], v[204:207], 0
    ds_read_b128 v[200:203], v12 offset:0
    v_mfma_f32_16x16x32_bf16 v[60:63], v[132:135], v[204:207], 0
    s_waitcnt lgkmcnt(3)
    v_mfma_f32_16x16x32_bf16 v[64:67], v[128:131], v[208:211], 0
    ds_read_b128 v[204:207], v12 offset:2048
    v_mfma_f32_16x16x32_bf16 v[72:75], v[132:135], v[208:211], 0
    v_mfma_f32_16x16x32_bf16 v[68:71], v[128:131], v[212:215], 0
    ds_read_b128 v[208:211], v12 offset:4096
    v_mfma_f32_16x16x32_bf16 v[76:79], v[132:135], v[212:215], 0
    s_waitcnt lgkmcnt(3)
    v_mfma_f32_16x16x32_bf16 v[80:83], v[128:131], v[192:195], 0
    ds_read_b128 v[212:215], v12 offset:6144
    v_mfma_f32_16x16x32_bf16 v[88:91], v[132:135], v[192:195], 0
    v_mfma_f32_16x16x32_bf16 v[84:87], v[128:131], v[196:199], 0
    ds_read_b128 v[192:195], v12 offset:8192
    v_mfma_f32_16x16x32_bf16 v[92:95], v[132:135], v[196:199], 0
    s_waitcnt lgkmcnt(3)
    s_waitcnt vmcnt(12)
    v_mfma_f32_16x16x32_bf16 v[32:35], v[136:139], v[200:203], v[32:35]
    ds_read_b128 v[196:199], v12 offset:10240
    v_mfma_f32_16x16x32_bf16 v[40:43], v[140:143], v[200:203], v[40:43]
    v_mfma_f32_16x16x32_bf16 v[36:39], v[136:139], v[204:207], v[36:39]
    ds_read_b128 v[200:203], v12 offset:12288
    v_mfma_f32_16x16x32_bf16 v[44:47], v[140:143], v[204:207], v[44:47]
    s_waitcnt lgkmcnt(3)
    v_mfma_f32_16x16x32_bf16 v[48:51], v[136:139], v[208:211], v[48:51]
    ds_read_b128 v[204:207], v12 offset:14336
    v_mfma_f32_16x16x32_bf16 v[56:59], v[140:143], v[208:211], v[56:59]
    v_mfma_f32_16x16x32_bf16 v[52:55], v[136:139], v[212:215], v[52:55]
    ds_read_b128 v[208:211], v11 offset:16384
    v_mfma_f32_16x16x32_bf16 v[60:63], v[140:143], v[212:215], v[60:63]
    s_waitcnt lgkmcnt(3)
    v_mfma_f32_16x16x32_bf16 v[64:67], v[136:139], v[192:195], v[64:67]
    ds_read_b128 v[212:215], v11 offset:18432
    v_mfma_f32_16x16x32_bf16 v[72:75], v[140:143], v[192:195], v[72:75]
    v_mfma_f32_16x16x32_bf16 v[68:71], v[136:139], v[196:199], v[68:71]
    ds_read_b128 v[192:195], v11 offset:20480
    v_mfma_f32_16x16x32_bf16 v[76:79], v[140:143], v[196:199], v[76:79]
    s_waitcnt lgkmcnt(3)
    v_mfma_f32_16x16x32_bf16 v[80:83], v[136:139], v[200:203], v[80:83]
    ds_read_b128 v[196:199], v11 offset:22528
    v_mfma_f32_16x16x32_bf16 v[88:91], v[140:143], v[200:203], v[88:91]
    v_mfma_f32_16x16x32_bf16 v[84:87], v[136:139], v[204:207], v[84:87]
    ds_read_b128 v[200:203], v11 offset:24576
    v_mfma_f32_16x16x32_bf16 v[92:95], v[140:143], v[204:207], v[92:95]
    s_waitcnt lgkmcnt(3)
    s_waitcnt vmcnt(10)
    v_mfma_f32_16x16x32_bf16 v[32:35], v[144:147], v[208:211], v[32:35]
    ds_read_b128 v[204:207], v11 offset:26624
    v_mfma_f32_16x16x32_bf16 v[40:43], v[148:151], v[208:211], v[40:43]
    v_mfma_f32_16x16x32_bf16 v[36:39], v[144:147], v[212:215], v[36:39]
    ds_read_b128 v[208:211], v11 offset:28672
    v_mfma_f32_16x16x32_bf16 v[44:47], v[148:151], v[212:215], v[44:47]
    s_waitcnt lgkmcnt(3)
    v_mfma_f32_16x16x32_bf16 v[48:51], v[144:147], v[192:195], v[48:51]
    ds_read_b128 v[212:215], v11 offset:30720
    v_mfma_f32_16x16x32_bf16 v[56:59], v[148:151], v[192:195], v[56:59]
    v_mfma_f32_16x16x32_bf16 v[52:55], v[144:147], v[196:199], v[52:55]
    ds_read_b128 v[192:195], v12 offset:16384
    v_mfma_f32_16x16x32_bf16 v[60:63], v[148:151], v[196:199], v[60:63]
    s_waitcnt lgkmcnt(3)
    v_mfma_f32_16x16x32_bf16 v[64:67], v[144:147], v[200:203], v[64:67]
    ds_read_b128 v[196:199], v12 offset:18432
    v_mfma_f32_16x16x32_bf16 v[72:75], v[148:151], v[200:203], v[72:75]
    v_mfma_f32_16x16x32_bf16 v[68:71], v[144:147], v[204:207], v[68:71]
    ds_read_b128 v[200:203], v12 offset:20480
    v_mfma_f32_16x16x32_bf16 v[76:79], v[148:151], v[204:207], v[76:79]
    s_waitcnt lgkmcnt(3)
    v_mfma_f32_16x16x32_bf16 v[80:83], v[144:147], v[208:211], v[80:83]
    ds_read_b128 v[204:207], v12 offset:22528
    v_mfma_f32_16x16x32_bf16 v[88:91], v[148:151], v[208:211], v[88:91]
    v_mfma_f32_16x16x32_bf16 v[84:87], v[144:147], v[212:215], v[84:87]
    ds_read_b128 v[208:211], v12 offset:24576
    v_mfma_f32_16x16x32_bf16 v[92:95], v[148:151], v[212:215], v[92:95]
    s_waitcnt lgkmcnt(3)
    s_waitcnt vmcnt(8)
    v_mfma_f32_16x16x32_bf16 v[32:35], v[152:155], v[192:195], v[32:35]
    ds_read_b128 v[212:215], v12 offset:26624
    v_mfma_f32_16x16x32_bf16 v[40:43], v[156:159], v[192:195], v[40:43]
    v_mfma_f32_16x16x32_bf16 v[36:39], v[152:155], v[196:199], v[36:39]
    ds_read_b128 v[192:195], v12 offset:28672
    v_mfma_f32_16x16x32_bf16 v[44:47], v[156:159], v[196:199], v[44:47]
    s_waitcnt lgkmcnt(3)
    v_mfma_f32_16x16x32_bf16 v[48:51], v[152:155], v[200:203], v[48:51]
    ds_read_b128 v[196:199], v12 offset:30720
    v_mfma_f32_16x16x32_bf16 v[56:59], v[156:159], v[200:203], v[56:59]
    v_mfma_f32_16x16x32_bf16 v[52:55], v[152:155], v[204:207], v[52:55]
    ds_read_b128 v[200:203], v11 offset:32768
    v_mfma_f32_16x16x32_bf16 v[60:63], v[156:159], v[204:207], v[60:63]
    s_waitcnt lgkmcnt(3)
    v_mfma_f32_16x16x32_bf16 v[64:67], v[152:155], v[208:211], v[64:67]
    ds_read_b128 v[204:207], v11 offset:34816
    v_mfma_f32_16x16x32_bf16 v[72:75], v[156:159], v[208:211], v[72:75]
    v_mfma_f32_16x16x32_bf16 v[68:71], v[152:155], v[212:215], v[68:71]
    ds_read_b128 v[208:211], v11 offset:36864
    v_mfma_f32_16x16x32_bf16 v[76:79], v[156:159], v[212:215], v[76:79]
    s_waitcnt lgkmcnt(3)
    v_mfma_f32_16x16x32_bf16 v[80:83], v[152:155], v[192:195], v[80:83]
    ds_read_b128 v[212:215], v11 offset:38912
    v_mfma_f32_16x16x32_bf16 v[88:91], v[156:159], v[192:195], v[88:91]
    v_mfma_f32_16x16x32_bf16 v[84:87], v[152:155], v[196:199], v[84:87]
    ds_read_b128 v[192:195], v11 offset:40960
    v_mfma_f32_16x16x32_bf16 v[92:95], v[156:159], v[196:199], v[92:95]
    s_waitcnt lgkmcnt(3)
    s_waitcnt vmcnt(6)
    v_mfma_f32_16x16x32_bf16 v[32:35], v[160:163], v[200:203], v[32:35]
    ds_read_b128 v[196:199], v11 offset:43008
    v_mfma_f32_16x16x32_bf16 v[40:43], v[164:167], v[200:203], v[40:43]
    v_mfma_f32_16x16x32_bf16 v[36:39], v[160:163], v[204:207], v[36:39]
    ds_read_b128 v[200:203], v11 offset:45056
    v_mfma_f32_16x16x32_bf16 v[44:47], v[164:167], v[204:207], v[44:47]
    s_waitcnt lgkmcnt(3)
    v_mfma_f32_16x16x32_bf16 v[48:51], v[160:163], v[208:211], v[48:51]
    ds_read_b128 v[204:207], v11 offset:47104
    v_mfma_f32_16x16x32_bf16 v[56:59], v[164:167], v[208:211], v[56:59]
    v_mfma_f32_16x16x32_bf16 v[52:55], v[160:163], v[212:215], v[52:55]
    ds_read_b128 v[208:211], v12 offset:32768
    v_mfma_f32_16x16x32_bf16 v[60:63], v[164:167], v[212:215], v[60:63]
    s_waitcnt lgkmcnt(3)
    v_mfma_f32_16x16x32_bf16 v[64:67], v[160:163], v[192:195], v[64:67]
    ds_read_b128 v[212:215], v12 offset:34816
    ds_read_b32 v14, v8 offset:0
    v_mfma_f32_16x16x32_bf16 v[72:75], v[164:167], v[192:195], v[72:75]
    v_mfma_f32_16x16x32_bf16 v[68:71], v[160:163], v[196:199], v[68:71]
    ds_read_b128 v[192:195], v12 offset:36864
    v_mfma_f32_16x16x32_bf16 v[76:79], v[164:167], v[196:199], v[76:79]
    s_waitcnt lgkmcnt(4)
    v_mfma_f32_16x16x32_bf16 v[80:83], v[160:163], v[200:203], v[80:83]
    ds_read_b128 v[196:199], v12 offset:38912
    v_mfma_f32_16x16x32_bf16 v[88:91], v[164:167], v[200:203], v[88:91]
    v_mfma_f32_16x16x32_bf16 v[84:87], v[160:163], v[204:207], v[84:87]
    ds_read_b128 v[200:203], v12 offset:40960
    v_mfma_f32_16x16x32_bf16 v[92:95], v[164:167], v[204:207], v[92:95]
    s_waitcnt lgkmcnt(4)
    s_waitcnt vmcnt(4)
    v_mfma_f32_16x16x32_bf16 v[32:35], v[168:171], v[208:211], v[32:35]
    ds_read_b128 v[204:207], v12 offset:43008
    s_waitcnt lgkmcnt(4)
    v_cmp_gt_u32 vcc, 11, v14
    s_cbranch_vccz L_ack_go
L_ack:
    ds_read_b32 v14, v8 offset:0
    s_waitcnt lgkmcnt(0)
    v_cmp_gt_u32 vcc, 11, v14
    s_cbranch_vccnz L_ack
L_ack_go:
    s_cmp_eq_u32 s41, 3
    s_cbranch_scc1 L_no_l2a
    buffer_load_dwordx4 v[112:115], v27, s[44:47], s50 offen offset:0 sc1
    buffer_load_dwordx4 v[116:119], v27, s[44:47], s50 offen offset:2048 sc1
L_no_l2a:
    buffer_load_dwordx4 v[96:99], v27, s[44:47], s48 offen offset:0 sc1
    v_mfma_f32_16x16x32_bf16 v[40:43], v[172:175], v[208:211], v[40:43]
    v_mfma_f32_16x16x32_bf16 v[36:39], v[168:171], v[212:215], v[36:39]
    ds_read_b128 v[208:211], v12 offset:45056
    buffer_load_dwordx4 v[100:103], v27, s[44:47], s48 offen offset:2048 sc1
    v_mfma_f32_16x16x32_bf16 v[44:47], v[172:175], v[212:215], v[44:47]
    s_waitcnt lgkmcnt(3)
    v_mfma_f32_16x16x32_bf16 v[48:51], v[168:171], v[192:195], v[48:51]
    ds_read_b128 v[212:215], v12 offset:47104
    buffer_load_dwordx4 v[104:107], v27, s[44:47], s49 offen offset:0 sc1
    v_mfma_f32_16x16x32_bf16 v[56:59], v[172:175], v[192:195], v[56:59]
    v_mfma_f32_16x16x32_bf16 v[52:55], v[168:171], v[196:199], v[52:55]
    ds_read_b128 v[192:195], v11 offset:49152
    buffer_load_dwordx4 v[108:111], v27, s[44:47], s49 offen offset:2048 sc1
    v_mfma_f32_16x16x32_bf16 v[60:63], v[172:175], v[196:199], v[60:63]
    s_waitcnt lgkmcnt(3)
    v_mfma_f32_16x16x32_bf16 v[64:67], v[168:171], v[200:203], v[64:67]
    ds_read_b128 v[196:199], v11 offset:51200
    v_mfma_f32_16x16x32_bf16 v[72:75], v[172:175], v[200:203], v[72:75]
    v_mfma_f32_16x16x32_bf16 v[68:71], v[168:171], v[204:207], v[68:71]
    ds_read_b128 v[200:203], v11 offset:53248
    v_mfma_f32_16x16x32_bf16 v[76:79], v[172:175], v[204:207], v[76:79]
    s_waitcnt lgkmcnt(3)
    v_mfma_f32_16x16x32_bf16 v[80:83], v[168:171], v[208:211], v[80:83]
    ds_read_b128 v[204:207], v11 offset:55296
    v_mfma_f32_16x16x32_bf16 v[88:91], v[172:175], v[208:211], v[88:91]
    v_mfma_f32_16x16x32_bf16 v[84:87], v[168:171], v[212:215], v[84:87]
    ds_read_b128 v[208:211], v11 offset:57344
    v_mfma_f32_16x16x32_bf16 v[92:95], v[172:175], v[212:215], v[92:95]
    s_waitcnt lgkmcnt(3)
    s_waitcnt vmcnt(6)
    v_mfma_f32_16x16x32_bf16 v[32:35], v[176:179], v[192:195], v[32:35]
    ds_read_b128 v[212:215], v11 offset:59392
    v_mfma_f32_16x16x32_bf16 v[40:43], v[180:183], v[192:195], v[40:43]
    v_mfma_f32_16x16x32_bf16 v[36:39], v[176:179], v[196:199], v[36:39]
    ds_read_b128 v[192:195], v11 offset:61440
    v_mfma_f32_16x16x32_bf16 v[44:47], v[180:183], v[196:199], v[44:47]
    s_waitcnt lgkmcnt(3)
    v_mfma_f32_16x16x32_bf16 v[48:51], v[176:179], v[200:203], v[48:51]
    ds_read_b128 v[196:199], v11 offset:63488
    v_mfma_f32_16x16x32_bf16 v[56:59], v[180:183], v[200:203], v[56:59]
    v_mfma_f32_16x16x32_bf16 v[52:55], v[176:179], v[204:207], v[52:55]
    ds_read_b128 v[200:203], v12 offset:49152
    v_mfma_f32_16x16x32_bf16 v[60:63], v[180:183], v[204:207], v[60:63]
    s_waitcnt lgkmcnt(3)
    v_mfma_f32_16x16x32_bf16 v[64:67], v[176:179], v[208:211], v[64:67]
    ds_read_b128 v[204:207], v12 offset:51200
    v_mfma_f32_16x16x32_bf16 v[72:75], v[180:183], v[208:211], v[72:75]
    v_mfma_f32_16x16x32_bf16 v[68:71], v[176:179], v[212:215], v[68:71]
    ds_read_b128 v[208:211], v12 offset:53248
    v_mfma_f32_16x16x32_bf16 v[76:79], v[180:183], v[212:215], v[76:79]
    s_waitcnt lgkmcnt(3)
    v_mfma_f32_16x16x32_bf16 v[80:83], v[176:179], v[192:195], v[80:83]
    ds_read_b128 v[212:215], v12 offset:55296
    ds_read_b32 v14, v16 offset:16
    v_mfma_f32_16x16x32_bf16 v[88:91], v[180:183], v[192:195], v[88:91]
    v_mfma_f32_16x16x32_bf16 v[84:87], v[176:179], v[196:199], v[84:87]
    ds_read_b128 v[192:195], v12 offset:57344
    v_mfma_f32_16x16x32_bf16 v[92:95], v[180:183], v[196:199], v[92:95]
    s_waitcnt lgkmcnt(4)
    s_waitcnt vmcnt(4)
    v_mfma_f32_16x16x32_bf16 v[32:35], v[184:187], v[200:203], v[32:35]
    ds_read_b128 v[196:199], v12 offset:59392
    v_mfma_f32_16x16x32_bf16 v[40:43], v[188:191], v[200:203], v[40:43]
    v_mfma_f32_16x16x32_bf16 v[36:39], v[184:187], v[204:207], v[36:39]
    ds_read_b128 v[200:203], v12 offset:61440
    v_mfma_f32_16x16x32_bf16 v[44:47], v[188:191], v[204:207], v[44:47]
    s_waitcnt lgkmcnt(4)
    v_mfma_f32_16x16x32_bf16 v[48:51], v[184:187], v[208:211], v[48:51]
    ds_read_b128 v[204:207], v12 offset:63488
    s_waitcnt lgkmcnt(4)
    v_cmp_gt_u32 vcc, 9, v14
    s_cbranch_vccz L_wd_go
L_wd:
    ds_read_b32 v14, v16 offset:16
    s_waitcnt lgkmcnt(0)
    v_cmp_gt_u32 vcc, 9, v14
    s_cbranch_vccnz L_wd
L_wd_go:
    v_mfma_f32_16x16x32_bf16 v[56:59], v[188:191], v[208:211], v[56:59]
    v_mfma_f32_16x16x32_bf16 v[52:55], v[184:187], v[212:215], v[52:55]
    ds_read_b64_tr_b16 v[208:209], v246 offset:49152
    v_mfma_f32_16x16x32_bf16 v[60:63], v[188:191], v[212:215], v[60:63]
    ds_read_b64_tr_b16 v[210:211], v246 offset:53248
    s_waitcnt lgkmcnt(4)
    v_mfma_f32_16x16x32_bf16 v[64:67], v[184:187], v[192:195], v[64:67]
    ds_read_b64_tr_b16 v[212:213], v247 offset:49152
    v_mfma_f32_16x16x32_bf16 v[72:75], v[188:191], v[192:195], v[72:75]
    ds_read_b64_tr_b16 v[214:215], v247 offset:53248
    v_mfma_f32_16x16x32_bf16 v[68:71], v[184:187], v[196:199], v[68:71]
    ds_read_b64_tr_b16 v[192:193], v244 offset:50176
    v_mfma_f32_16x16x32_bf16 v[76:79], v[188:191], v[196:199], v[76:79]
    ds_read_b64_tr_b16 v[194:195], v244 offset:54272
    s_waitcnt lgkmcnt(6)
    v_mfma_f32_16x16x32_bf16 v[80:83], v[184:187], v[200:203], v[80:83]
    ds_read_b64_tr_b16 v[196:197], v245 offset:50176
    v_mfma_f32_16x16x32_bf16 v[88:91], v[188:191], v[200:203], v[88:91]
    ds_read_b64_tr_b16 v[198:199], v245 offset:54272
    v_mfma_f32_16x16x32_bf16 v[84:87], v[184:187], v[204:207], v[84:87]
    ds_read_b64_tr_b16 v[200:201], v246 offset:50176
    v_mfma_f32_16x16x32_bf16 v[92:95], v[188:191], v[204:207], v[92:95]
    ds_read_b64_tr_b16 v[202:203], v246 offset:54272
    s_waitcnt lgkmcnt(6)
    s_waitcnt vmcnt(2)
    v_mfma_f32_16x16x32_bf16 v[48:51], v[96:99], v[208:211], v[48:51]
    ds_read_b64_tr_b16 v[204:205], v247 offset:50176
    ds_read_b32 v14, v8 offset:0
    v_mfma_f32_16x16x32_bf16 v[56:59], v[100:103], v[208:211], v[56:59]
    ds_read_b64_tr_b16 v[206:207], v247 offset:54272
    v_mfma_f32_16x16x32_bf16 v[52:55], v[96:99], v[212:215], v[52:55]
    ds_read_b64_tr_b16 v[208:209], v242 offset:16384
    v_mfma_f32_16x16x32_bf16 v[60:63], v[100:103], v[212:215], v[60:63]
    ds_read_b64_tr_b16 v[210:211], v242 offset:20480
    s_waitcnt lgkmcnt(7)
    v_mfma_f32_16x16x32_bf16 v[64:67], v[96:99], v[192:195], v[64:67]
    ds_read_b64_tr_b16 v[212:213], v243 offset:16384
    v_mfma_f32_16x16x32_bf16 v[72:75], v[100:103], v[192:195], v[72:75]
    ds_read_b64_tr_b16 v[214:215], v243 offset:20480
    v_mfma_f32_16x16x32_bf16 v[68:71], v[96:99], v[196:199], v[68:71]
    ds_read_b64_tr_b16 v[192:193], v240 offset:17408
    v_mfma_f32_16x16x32_bf16 v[76:79], v[100:103], v[196:199], v[76:79]
    ds_read_b64_tr_b16 v[194:195], v240 offset:21504
    s_waitcnt lgkmcnt(6)
    v_mfma_f32_16x16x32_bf16 v[80:83], v[96:99], v[200:203], v[80:83]
    ds_read_b64_tr_b16 v[196:197], v241 offset:17408
    v_cmp_gt_u32 vcc, 12, v14
    s_cbranch_vccz L_gu_go
L_gu:
    ds_read_b32 v14, v8 offset:0
    s_waitcnt lgkmcnt(0)
    v_cmp_gt_u32 vcc, 12, v14
    s_cbranch_vccnz L_gu
L_gu_go:
    s_cmp_lg_u32 s41, 3
    s_cbranch_scc1 L_no_l2b
    buffer_load_dwordx4 v[112:115], v27, s[44:47], s50 offen offset:0 sc1
    buffer_load_dwordx4 v[116:119], v27, s[44:47], s50 offen offset:2048 sc1
L_no_l2b:
    v_mfma_f32_16x16x32_bf16 v[88:91], v[100:103], v[200:203], v[88:91]
    ds_read_b64_tr_b16 v[198:199], v241 offset:21504
    v_mfma_f32_16x16x32_bf16 v[84:87], v[96:99], v[204:207], v[84:87]
    ds_read_b64_tr_b16 v[200:201], v242 offset:17408
    buffer_load_dwordx4 v[128:131], v27, s[44:47], s51 offen offset:0 sc1
    v_mfma_f32_16x16x32_bf16 v[92:95], v[100:103], v[204:207], v[92:95]
    ds_read_b64_tr_b16 v[202:203], v242 offset:21504
    s_waitcnt lgkmcnt(6)
    s_waitcnt vmcnt(1)
    v_mfma_f32_16x16x32_bf16 v[48:51], v[104:107], v[208:211], v[48:51]
    ds_read_b64_tr_b16 v[204:205], v243 offset:17408
    buffer_load_dwordx4 v[132:135], v27, s[44:47], s51 offen offset:2048 sc1
    v_mfma_f32_16x16x32_bf16 v[56:59], v[108:111], v[208:211], v[56:59]
    ds_read_b64_tr_b16 v[206:207], v243 offset:21504
    v_mfma_f32_16x16x32_bf16 v[52:55], v[104:107], v[212:215], v[52:55]
    ds_read_b64_tr_b16 v[208:209], v242 offset:24576
    buffer_load_dwordx4 v[136:139], v27, s[44:47], s52 offen offset:0 sc1
    v_mfma_f32_16x16x32_bf16 v[60:63], v[108:111], v[212:215], v[60:63]
    ds_read_b64_tr_b16 v[210:211], v242 offset:28672
    s_waitcnt lgkmcnt(6)
    v_mfma_f32_16x16x32_bf16 v[64:67], v[104:107], v[192:195], v[64:67]
    ds_read_b64_tr_b16 v[212:213], v243 offset:24576
    buffer_load_dwordx4 v[140:143], v27, s[44:47], s52 offen offset:2048 sc1
    v_mfma_f32_16x16x32_bf16 v[72:75], v[108:111], v[192:195], v[72:75]
    ds_read_b64_tr_b16 v[214:215], v243 offset:28672
    v_mfma_f32_16x16x32_bf16 v[68:71], v[104:107], v[196:199], v[68:71]
    ds_read_b64_tr_b16 v[192:193], v240 offset:25600
    buffer_load_dwordx4 v[144:147], v27, s[44:47], s53 offen offset:0 sc1
    v_mfma_f32_16x16x32_bf16 v[76:79], v[108:111], v[196:199], v[76:79]
    ds_read_b64_tr_b16 v[194:195], v240 offset:29696
    s_waitcnt lgkmcnt(6)
    v_mfma_f32_16x16x32_bf16 v[80:83], v[104:107], v[200:203], v[80:83]
    ds_read_b64_tr_b16 v[196:197], v241 offset:25600
    buffer_load_dwordx4 v[148:151], v27, s[44:47], s53 offen offset:2048 sc1
    v_mfma_f32_16x16x32_bf16 v[88:91], v[108:111], v[200:203], v[88:91]
    ds_read_b64_tr_b16 v[198:199], v241 offset:29696
    v_mfma_f32_16x16x32_bf16 v[84:87], v[104:107], v[204:207], v[84:87]
    ds_read_b64_tr_b16 v[200:201], v242 offset:25600
    buffer_load_dwordx4 v[152:155], v27, s[44:47], s54 offen offset:0 sc1
    s_waitcnt vmcnt(7)
    v_mfma_f32_16x16x32_bf16 v[92:95], v[108:111], v[204:207], v[92:95]
    ds_read_b64_tr_b16 v[202:203], v242 offset:29696
    s_waitcnt lgkmcnt(6)
    v_mfma_f32_16x16x32_bf16 v[48:51], v[112:115], v[208:211], v[48:51]
    ds_read_b64_tr_b16 v[204:205], v243 offset:25600
    buffer_load_dwordx4 v[156:159], v27, s[44:47], s54 offen offset:2048 sc1
    v_mfma_f32_16x16x32_bf16 v[56:59], v[116:119], v[208:211], v[56:59]
    ds_read_b64_tr_b16 v[206:207], v243 offset:29696
    v_mfma_f32_16x16x32_bf16 v[52:55], v[112:115], v[212:215], v[52:55]
    ds_read_b64_tr_b16 v[208:209], v242 offset:32768
    buffer_load_dwordx4 v[160:163], v27, s[44:47], s55 offen offset:0 sc1
    v_mfma_f32_16x16x32_bf16 v[60:63], v[116:119], v[212:215], v[60:63]
    ds_read_b64_tr_b16 v[210:211], v242 offset:36864
    s_waitcnt lgkmcnt(6)
    v_mfma_f32_16x16x32_bf16 v[64:67], v[112:115], v[192:195], v[64:67]
    ds_read_b64_tr_b16 v[212:213], v243 offset:32768
    buffer_load_dwordx4 v[164:167], v27, s[44:47], s55 offen offset:2048 sc1
    v_mfma_f32_16x16x32_bf16 v[72:75], v[116:119], v[192:195], v[72:75]
    ds_read_b64_tr_b16 v[214:215], v243 offset:36864
    v_mfma_f32_16x16x32_bf16 v[68:71], v[112:115], v[196:199], v[68:71]
    ds_read_b64_tr_b16 v[192:193], v240 offset:33792
    buffer_load_dwordx4 v[168:171], v27, s[44:47], s56 offen offset:0 sc1
    v_mfma_f32_16x16x32_bf16 v[76:79], v[116:119], v[196:199], v[76:79]
    ds_read_b64_tr_b16 v[194:195], v240 offset:37888
    s_waitcnt lgkmcnt(6)
    v_mfma_f32_16x16x32_bf16 v[80:83], v[112:115], v[200:203], v[80:83]
    ds_read_b64_tr_b16 v[196:197], v241 offset:33792
    buffer_load_dwordx4 v[172:175], v27, s[44:47], s56 offen offset:2048 sc1
    v_mfma_f32_16x16x32_bf16 v[88:91], v[116:119], v[200:203], v[88:91]
    ds_read_b64_tr_b16 v[198:199], v241 offset:37888
    v_mfma_f32_16x16x32_bf16 v[84:87], v[112:115], v[204:207], v[84:87]
    ds_read_b64_tr_b16 v[200:201], v242 offset:33792
    buffer_load_dwordx4 v[176:179], v27, s[44:47], s57 offen offset:0 sc1
    v_mfma_f32_16x16x32_bf16 v[92:95], v[116:119], v[204:207], v[92:95]
    ds_read_b64_tr_b16 v[202:203], v242 offset:37888
    s_waitcnt lgkmcnt(6)
    s_waitcnt vmcnt(11)
    v_mfma_f32_16x16x32_bf16 v[48:51], v[128:131], v[208:211], v[48:51]
    ds_read_b64_tr_b16 v[204:205], v243 offset:33792
    buffer_load_dwordx4 v[180:183], v27, s[44:47], s57 offen offset:2048 sc1
    v_mfma_f32_16x16x32_bf16 v[56:59], v[132:135], v[208:211], v[56:59]
    ds_read_b64_tr_b16 v[206:207], v243 offset:37888
    v_mfma_f32_16x16x32_bf16 v[52:55], v[128:131], v[212:215], v[52:55]
    ds_read_b64_tr_b16 v[208:209], v242 offset:40960
    buffer_load_dwordx4 v[184:187], v27, s[44:47], s58 offen offset:0 sc1
    v_mfma_f32_16x16x32_bf16 v[60:63], v[132:135], v[212:215], v[60:63]
    ds_read_b64_tr_b16 v[210:211], v242 offset:45056
    s_waitcnt lgkmcnt(6)
    v_mfma_f32_16x16x32_bf16 v[64:67], v[128:131], v[192:195], v[64:67]
    ds_read_b64_tr_b16 v[212:213], v243 offset:40960
    buffer_load_dwordx4 v[188:191], v27, s[44:47], s58 offen offset:2048 sc1
    ds_read_b32 v14, v16 offset:48
    v_mfma_f32_16x16x32_bf16 v[72:75], v[132:135], v[192:195], v[72:75]
    ds_read_b64_tr_b16 v[214:215], v243 offset:45056
    v_mfma_f32_16x16x32_bf16 v[68:71], v[128:131], v[196:199], v[68:71]
    ds_read_b64_tr_b16 v[192:193], v240 offset:41984
    v_mfma_f32_16x16x32_bf16 v[76:79], v[132:135], v[196:199], v[76:79]
    ds_read_b64_tr_b16 v[194:195], v240 offset:46080
    s_waitcnt lgkmcnt(7)
    v_mfma_f32_16x16x32_bf16 v[80:83], v[128:131], v[200:203], v[80:83]
    ds_read_b64_tr_b16 v[196:197], v241 offset:41984
    v_mfma_f32_16x16x32_bf16 v[88:91], v[132:135], v[200:203], v[88:91]
    ds_read_b64_tr_b16 v[198:199], v241 offset:46080
    v_mfma_f32_16x16x32_bf16 v[84:87], v[128:131], v[204:207], v[84:87]
    ds_read_b64_tr_b16 v[200:201], v242 offset:41984
    v_mfma_f32_16x16x32_bf16 v[92:95], v[132:135], v[204:207], v[92:95]
    ds_read_b64_tr_b16 v[202:203], v242 offset:46080
    s_waitcnt lgkmcnt(6)
    s_waitcnt vmcnt(12)
    v_mfma_f32_16x16x32_bf16 v[48:51], v[136:139], v[208:211], v[48:51]
    ds_read_b64_tr_b16 v[204:205], v243 offset:41984
    v_cmp_gt_u32 vcc, 13, v14
    s_cbranch_vccz L_dall_go
L_dall:
    ds_read_b32 v14, v16 offset:48
    s_waitcnt lgkmcnt(0)
    v_cmp_gt_u32 vcc, 13, v14
    s_cbranch_vccnz L_dall
L_dall_go:
    v_mfma_f32_16x16x32_bf16 v[56:59], v[140:143], v[208:211], v[56:59]
    ds_read_b64_tr_b16 v[206:207], v243 offset:46080
    v_mfma_f32_16x16x32_bf16 v[52:55], v[136:139], v[212:215], v[52:55]
    ds_read_b64_tr_b16 v[208:209], v246 offset:0
    v_mfma_f32_16x16x32_bf16 v[60:63], v[140:143], v[212:215], v[60:63]
    ds_read_b64_tr_b16 v[210:211], v246 offset:4096
    s_waitcnt lgkmcnt(6)
    v_mfma_f32_16x16x32_bf16 v[64:67], v[136:139], v[192:195], v[64:67]
    ds_read_b64_tr_b16 v[212:213], v247 offset:0
    v_mfma_f32_16x16x32_bf16 v[72:75], v[140:143], v[192:195], v[72:75]
    ds_read_b64_tr_b16 v[214:215], v247 offset:4096
    v_mfma_f32_16x16x32_bf16 v[68:71], v[136:139], v[196:199], v[68:71]
    ds_read_b64_tr_b16 v[192:193], v246 offset:8192
    v_mfma_f32_16x16x32_bf16 v[76:79], v[140:143], v[196:199], v[76:79]
    ds_read_b64_tr_b16 v[194:195], v246 offset:12288
    s_waitcnt lgkmcnt(6)
    v_mfma_f32_16x16x32_bf16 v[80:83], v[136:139], v[200:203], v[80:83]
    ds_read_b64_tr_b16 v[196:197], v247 offset:8192
    v_mfma_f32_16x16x32_bf16 v[88:91], v[140:143], v[200:203], v[88:91]
    ds_read_b64_tr_b16 v[198:199], v247 offset:12288
    v_mfma_f32_16x16x32_bf16 v[84:87], v[136:139], v[204:207], v[84:87]
    ds_read_b64_tr_b16 v[200:201], v246 offset:16384
    v_mfma_f32_16x16x32_bf16 v[92:95], v[140:143], v[204:207], v[92:95]
    ds_read_b64_tr_b16 v[202:203], v246 offset:20480
    s_waitcnt lgkmcnt(6)
    s_waitcnt vmcnt(10)
    v_mfma_f32_16x16x32_bf16 v[48:51], v[144:147], v[208:211], v[48:51]
    ds_read_b64_tr_b16 v[204:205], v247 offset:16384
    v_mfma_f32_16x16x32_bf16 v[56:59], v[148:151], v[208:211], v[56:59]
    ds_read_b64_tr_b16 v[206:207], v247 offset:20480
    v_mfma_f32_16x16x32_bf16 v[52:55], v[144:147], v[212:215], v[52:55]
    ds_read_b64_tr_b16 v[208:209], v246 offset:24576
    s_add_u32 m0, s26, 32
    s_mov_b64 exec, 1
    buffer_load_dword off, s[28:31], 12 lds
    s_mov_b64 exec, -1
    v_mfma_f32_16x16x32_bf16 v[60:63], v[148:151], v[212:215], v[60:63]
    ds_read_b64_tr_b16 v[210:211], v246 offset:28672
    s_waitcnt lgkmcnt(6)
    s_waitcnt vmcnt(9)
    v_mfma_f32_16x16x32_bf16 v[48:51], v[152:155], v[192:195], v[48:51]
    ds_read_b64_tr_b16 v[212:213], v247 offset:24576
    v_mfma_f32_16x16x32_bf16 v[56:59], v[156:159], v[192:195], v[56:59]
    ds_read_b64_tr_b16 v[214:215], v247 offset:28672
    v_mfma_f32_16x16x32_bf16 v[52:55], v[152:155], v[196:199], v[52:55]
    ds_read_b64_tr_b16 v[192:193], v246 offset:32768
    v_mfma_f32_16x16x32_bf16 v[60:63], v[156:159], v[196:199], v[60:63]
    ds_read_b64_tr_b16 v[194:195], v246 offset:36864
    s_waitcnt lgkmcnt(6)
    s_waitcnt vmcnt(7)
    v_mfma_f32_16x16x32_bf16 v[48:51], v[160:163], v[200:203], v[48:51]
    ds_read_b64_tr_b16 v[196:197], v247 offset:32768
    v_mfma_f32_16x16x32_bf16 v[56:59], v[164:167], v[200:203], v[56:59]
    ds_read_b64_tr_b16 v[198:199], v247 offset:36864
    v_mfma_f32_16x16x32_bf16 v[52:55], v[160:163], v[204:207], v[52:55]
    ds_read_b64_tr_b16 v[200:201], v246 offset:40960
    v_mfma_f32_16x16x32_bf16 v[60:63], v[164:167], v[204:207], v[60:63]
    ds_read_b64_tr_b16 v[202:203], v246 offset:45056
    s_waitcnt lgkmcnt(6)
    s_waitcnt vmcnt(5)
    v_mfma_f32_16x16x32_bf16 v[48:51], v[168:171], v[208:211], v[48:51]
    ds_read_b64_tr_b16 v[204:205], v247 offset:40960
    v_mfma_f32_16x16x32_bf16 v[56:59], v[172:175], v[208:211], v[56:59]
    ds_read_b64_tr_b16 v[206:207], v247 offset:45056
    v_mfma_f32_16x16x32_bf16 v[52:55], v[168:171], v[212:215], v[52:55]
    ds_read_b64_tr_b16 v[208:209], v244 offset:1024
    v_mfma_f32_16x16x32_bf16 v[60:63], v[172:175], v[212:215], v[60:63]
    ds_read_b64_tr_b16 v[210:211], v244 offset:5120
    s_waitcnt lgkmcnt(6)
    s_waitcnt vmcnt(3)
    v_mfma_f32_16x16x32_bf16 v[48:51], v[176:179], v[192:195], v[48:51]
    ds_read_b64_tr_b16 v[212:213], v245 offset:1024
    v_mfma_f32_16x16x32_bf16 v[56:59], v[180:183], v[192:195], v[56:59]
    ds_read_b64_tr_b16 v[214:215], v245 offset:5120
    v_mfma_f32_16x16x32_bf16 v[52:55], v[176:179], v[196:199], v[52:55]
    ds_read_b64_tr_b16 v[192:193], v244 offset:9216
    v_mfma_f32_16x16x32_bf16 v[60:63], v[180:183], v[196:199], v[60:63]
    ds_read_b64_tr_b16 v[194:195], v244 offset:13312
    s_waitcnt lgkmcnt(6)
    s_waitcnt vmcnt(1)
    v_mfma_f32_16x16x32_bf16 v[48:51], v[184:187], v[200:203], v[48:51]
    ds_read_b64_tr_b16 v[196:197], v245 offset:9216
    v_mfma_f32_16x16x32_bf16 v[56:59], v[188:191], v[200:203], v[56:59]
    ds_read_b64_tr_b16 v[198:199], v245 offset:13312
    v_mfma_f32_16x16x32_bf16 v[52:55], v[184:187], v[204:207], v[52:55]
    ds_read_b64_tr_b16 v[200:201], v244 offset:17408
    v_mfma_f32_16x16x32_bf16 v[60:63], v[188:191], v[204:207], v[60:63]
    ds_read_b64_tr_b16 v[202:203], v244 offset:21504
    s_waitcnt lgkmcnt(6)
    v_mfma_f32_16x16x32_bf16 v[64:67], v[144:147], v[208:211], v[64:67]
    ds_read_b64_tr_b16 v[204:205], v245 offset:17408
    v_mfma_f32_16x16x32_bf16 v[72:75], v[148:151], v[208:211], v[72:75]
    ds_read_b64_tr_b16 v[206:207], v245 offset:21504
    v_mfma_f32_16x16x32_bf16 v[68:71], v[144:147], v[212:215], v[68:71]
    ds_read_b64_tr_b16 v[208:209], v244 offset:25600
    v_mfma_f32_16x16x32_bf16 v[76:79], v[148:151], v[212:215], v[76:79]
    ds_read_b64_tr_b16 v[210:211], v244 offset:29696
    s_waitcnt lgkmcnt(6)
    v_mfma_f32_16x16x32_bf16 v[64:67], v[152:155], v[192:195], v[64:67]
    ds_read_b64_tr_b16 v[212:213], v245 offset:25600
    v_cvt_pk_bf16_f32 v216, v48, v49
    v_cvt_pk_bf16_f32 v217, v50, v51
    v_mfma_f32_16x16x32_bf16 v[72:75], v[156:159], v[192:195], v[72:75]
    ds_read_b64_tr_b16 v[214:215], v245 offset:29696
    v_mfma_f32_16x16x32_bf16 v[68:71], v[152:155], v[196:199], v[68:71]
    ds_read_b64_tr_b16 v[192:193], v244 offset:33792
    v_cvt_pk_bf16_f32 v218, v52, v53
    v_cvt_pk_bf16_f32 v219, v54, v55
    v_mfma_f32_16x16x32_bf16 v[76:79], v[156:159], v[196:199], v[76:79]
    ds_read_b64_tr_b16 v[194:195], v244 offset:37888
    s_waitcnt lgkmcnt(6)
    v_mfma_f32_16x16x32_bf16 v[64:67], v[160:163], v[200:203], v[64:67]
    ds_read_b64_tr_b16 v[196:197], v245 offset:33792
    v_cvt_pk_bf16_f32 v220, v56, v57
    v_cvt_pk_bf16_f32 v221, v58, v59
    buffer_store_dwordx4 v[216:219], v23, s[44:47], 0 offen offset:0 sc1
    v_mfma_f32_16x16x32_bf16 v[72:75], v[164:167], v[200:203], v[72:75]
    ds_read_b64_tr_b16 v[198:199], v245 offset:37888
    v_mfma_f32_16x16x32_bf16 v[68:71], v[160:163], v[204:207], v[68:71]
    ds_read_b64_tr_b16 v[200:201], v244 offset:41984
    v_cvt_pk_bf16_f32 v222, v60, v61
    v_cvt_pk_bf16_f32 v223, v62, v63
    v_mfma_f32_16x16x32_bf16 v[76:79], v[164:167], v[204:207], v[76:79]
    ds_read_b64_tr_b16 v[202:203], v244 offset:46080
    s_waitcnt lgkmcnt(6)
    v_mfma_f32_16x16x32_bf16 v[64:67], v[168:171], v[208:211], v[64:67]
    ds_read_b64_tr_b16 v[204:205], v245 offset:41984
    buffer_store_dwordx4 v[220:223], v23, s[44:47], 0 offen offset:2048 sc1
    v_mfma_f32_16x16x32_bf16 v[72:75], v[172:175], v[208:211], v[72:75]
    ds_read_b64_tr_b16 v[206:207], v245 offset:46080
    v_mfma_f32_16x16x32_bf16 v[68:71], v[168:171], v[212:215], v[68:71]
    ds_read_b64_tr_b16 v[208:209], v246 offset:1024
    v_mfma_f32_16x16x32_bf16 v[76:79], v[172:175], v[212:215], v[76:79]
    ds_read_b64_tr_b16 v[210:211], v246 offset:5120
    s_waitcnt lgkmcnt(6)
    v_mfma_f32_16x16x32_bf16 v[64:67], v[176:179], v[192:195], v[64:67]
    ds_read_b64_tr_b16 v[212:213], v247 offset:1024
    v_mfma_f32_16x16x32_bf16 v[72:75], v[180:183], v[192:195], v[72:75]
    ds_read_b64_tr_b16 v[214:215], v247 offset:5120
    v_mfma_f32_16x16x32_bf16 v[68:71], v[176:179], v[196:199], v[68:71]
    ds_read_b64_tr_b16 v[192:193], v246 offset:9216
    v_mfma_f32_16x16x32_bf16 v[76:79], v[180:183], v[196:199], v[76:79]
    ds_read_b64_tr_b16 v[194:195], v246 offset:13312
    s_waitcnt lgkmcnt(6)
    v_mfma_f32_16x16x32_bf16 v[64:67], v[184:187], v[200:203], v[64:67]
    ds_read_b64_tr_b16 v[196:197], v247 offset:9216
    v_mfma_f32_16x16x32_bf16 v[72:75], v[188:191], v[200:203], v[72:75]
    ds_read_b64_tr_b16 v[198:199], v247 offset:13312
    v_mfma_f32_16x16x32_bf16 v[68:71], v[184:187], v[204:207], v[68:71]
    ds_read_b64_tr_b16 v[200:201], v246 offset:17408
    v_mfma_f32_16x16x32_bf16 v[76:79], v[188:191], v[204:207], v[76:79]
    ds_read_b64_tr_b16 v[202:203], v246 offset:21504
    s_waitcnt lgkmcnt(6)
    v_mfma_f32_16x16x32_bf16 v[80:83], v[144:147], v[208:211], v[80:83]
    ds_read_b64_tr_b16 v[204:205], v247 offset:17408
    v_mfma_f32_16x16x32_bf16 v[88:91], v[148:151], v[208:211], v[88:91]
    ds_read_b64_tr_b16 v[206:207], v247 offset:21504
    v_mfma_f32_16x16x32_bf16 v[84:87], v[144:147], v[212:215], v[84:87]
    ds_read_b64_tr_b16 v[208:209], v246 offset:25600
    v_mfma_f32_16x16x32_bf16 v[92:95], v[148:151], v[212:215], v[92:95]
    ds_read_b64_tr_b16 v[210:211], v246 offset:29696
    s_waitcnt lgkmcnt(6)
    v_mfma_f32_16x16x32_bf16 v[80:83], v[152:155], v[192:195], v[80:83]
    ds_read_b64_tr_b16 v[212:213], v247 offset:25600
    v_cvt_pk_bf16_f32 v224, v64, v65
    v_cvt_pk_bf16_f32 v225, v66, v67
    v_mfma_f32_16x16x32_bf16 v[88:91], v[156:159], v[192:195], v[88:91]
    ds_read_b64_tr_b16 v[214:215], v247 offset:29696
    v_mfma_f32_16x16x32_bf16 v[84:87], v[152:155], v[196:199], v[84:87]
    ds_read_b64_tr_b16 v[192:193], v246 offset:33792
    v_cvt_pk_bf16_f32 v226, v68, v69
    v_cvt_pk_bf16_f32 v227, v70, v71
    v_mfma_f32_16x16x32_bf16 v[92:95], v[156:159], v[196:199], v[92:95]
    ds_read_b64_tr_b16 v[194:195], v246 offset:37888
    s_waitcnt lgkmcnt(6)
    v_mfma_f32_16x16x32_bf16 v[80:83], v[160:163], v[200:203], v[80:83]
    ds_read_b64_tr_b16 v[196:197], v247 offset:33792
    v_cvt_pk_bf16_f32 v228, v72, v73
    v_cvt_pk_bf16_f32 v229, v74, v75
    buffer_store_dwordx4 v[224:227], v24, s[44:47], 0 offen offset:0 sc1
    v_mfma_f32_16x16x32_bf16 v[88:91], v[164:167], v[200:203], v[88:91]
    ds_read_b64_tr_b16 v[198:199], v247 offset:37888
    v_mfma_f32_16x16x32_bf16 v[84:87], v[160:163], v[204:207], v[84:87]
    ds_read_b64_tr_b16 v[200:201], v246 offset:41984
    v_cvt_pk_bf16_f32 v230, v76, v77
    v_cvt_pk_bf16_f32 v231, v78, v79
    v_mfma_f32_16x16x32_bf16 v[92:95], v[164:167], v[204:207], v[92:95]
    ds_read_b64_tr_b16 v[202:203], v246 offset:46080
    s_waitcnt lgkmcnt(6)
    v_mfma_f32_16x16x32_bf16 v[80:83], v[168:171], v[208:211], v[80:83]
    ds_read_b64_tr_b16 v[204:205], v247 offset:41984
    buffer_store_dwordx4 v[228:231], v24, s[44:47], 0 offen offset:2048 sc1
    v_mfma_f32_16x16x32_bf16 v[88:91], v[172:175], v[208:211], v[88:91]
    ds_read_b64_tr_b16 v[206:207], v247 offset:46080
    v_mfma_f32_16x16x32_bf16 v[84:87], v[168:171], v[212:215], v[84:87]
    ds_read_b64_tr_b16 v[208:209], v244 offset:49152
    v_mfma_f32_16x16x32_bf16 v[92:95], v[172:175], v[212:215], v[92:95]
    ds_read_b64_tr_b16 v[210:211], v244 offset:53248
    s_waitcnt lgkmcnt(6)
    v_mfma_f32_16x16x32_bf16 v[80:83], v[176:179], v[192:195], v[80:83]
    ds_read_b64_tr_b16 v[212:213], v245 offset:49152
    v_mfma_f32_16x16x32_bf16 v[88:91], v[180:183], v[192:195], v[88:91]
    ds_read_b64_tr_b16 v[214:215], v245 offset:53248
    v_mfma_f32_16x16x32_bf16 v[84:87], v[176:179], v[196:199], v[84:87]
    ds_read_b64_tr_b16 v[192:193], v240 offset:16384
    v_mfma_f32_16x16x32_bf16 v[92:95], v[180:183], v[196:199], v[92:95]
    ds_read_b64_tr_b16 v[194:195], v240 offset:20480
    s_waitcnt lgkmcnt(6)
    v_mfma_f32_16x16x32_bf16 v[80:83], v[184:187], v[200:203], v[80:83]
    ds_read_b64_tr_b16 v[196:197], v241 offset:16384
    v_mfma_f32_16x16x32_bf16 v[88:91], v[188:191], v[200:203], v[88:91]
    ds_read_b64_tr_b16 v[198:199], v241 offset:20480
    v_mfma_f32_16x16x32_bf16 v[84:87], v[184:187], v[204:207], v[84:87]
    ds_read_b64_tr_b16 v[200:201], v240 offset:24576
    v_mfma_f32_16x16x32_bf16 v[92:95], v[188:191], v[204:207], v[92:95]
    ds_read_b64_tr_b16 v[202:203], v240 offset:28672
    s_waitcnt lgkmcnt(6)
    v_mfma_f32_16x16x32_bf16 v[32:35], v[96:99], v[208:211], v[32:35]
    ds_read_b64_tr_b16 v[204:205], v241 offset:24576
    v_mfma_f32_16x16x32_bf16 v[40:43], v[100:103], v[208:211], v[40:43]
    ds_read_b64_tr_b16 v[206:207], v241 offset:28672
    v_mfma_f32_16x16x32_bf16 v[36:39], v[96:99], v[212:215], v[36:39]
    ds_read_b64_tr_b16 v[208:209], v240 offset:32768
    v_mfma_f32_16x16x32_bf16 v[44:47], v[100:103], v[212:215], v[44:47]
    ds_read_b64_tr_b16 v[210:211], v240 offset:36864
    s_waitcnt lgkmcnt(6)
    v_mfma_f32_16x16x32_bf16 v[32:35], v[104:107], v[192:195], v[32:35]
    ds_read_b64_tr_b16 v[212:213], v241 offset:32768
    v_cvt_pk_bf16_f32 v232, v80, v81
    v_cvt_pk_bf16_f32 v233, v82, v83
    v_mfma_f32_16x16x32_bf16 v[40:43], v[108:111], v[192:195], v[40:43]
    ds_read_b64_tr_b16 v[214:215], v241 offset:36864
    v_mfma_f32_16x16x32_bf16 v[36:39], v[104:107], v[196:199], v[36:39]
    ds_read_b64_tr_b16 v[192:193], v240 offset:40960
    v_cvt_pk_bf16_f32 v234, v84, v85
    v_cvt_pk_bf16_f32 v235, v86, v87
    v_mfma_f32_16x16x32_bf16 v[44:47], v[108:111], v[196:199], v[44:47]
    ds_read_b64_tr_b16 v[194:195], v240 offset:45056
    s_waitcnt lgkmcnt(6)
    v_mfma_f32_16x16x32_bf16 v[32:35], v[112:115], v[200:203], v[32:35]
    ds_read_b64_tr_b16 v[196:197], v241 offset:40960
    v_cvt_pk_bf16_f32 v236, v88, v89
    v_cvt_pk_bf16_f32 v237, v90, v91
    buffer_store_dwordx4 v[232:235], v25, s[44:47], 0 offen offset:0 sc1
    v_mfma_f32_16x16x32_bf16 v[40:43], v[116:119], v[200:203], v[40:43]
    ds_read_b64_tr_b16 v[198:199], v241 offset:45056
    v_mfma_f32_16x16x32_bf16 v[36:39], v[112:115], v[204:207], v[36:39]
    ds_read_b64_tr_b16 v[200:201], v244 offset:0
    v_cvt_pk_bf16_f32 v238, v92, v93
    v_cvt_pk_bf16_f32 v239, v94, v95
    v_mfma_f32_16x16x32_bf16 v[44:47], v[116:119], v[204:207], v[44:47]
    ds_read_b64_tr_b16 v[202:203], v244 offset:4096
    s_waitcnt lgkmcnt(6)
    v_mfma_f32_16x16x32_bf16 v[32:35], v[128:131], v[208:211], v[32:35]
    ds_read_b64_tr_b16 v[204:205], v245 offset:0
    buffer_store_dwordx4 v[236:239], v25, s[44:47], 0 offen offset:2048 sc1
    v_mfma_f32_16x16x32_bf16 v[40:43], v[132:135], v[208:211], v[40:43]
    ds_read_b64_tr_b16 v[206:207], v245 offset:4096
    v_mfma_f32_16x16x32_bf16 v[36:39], v[128:131], v[212:215], v[36:39]
    ds_read_b64_tr_b16 v[208:209], v244 offset:8192
    v_mfma_f32_16x16x32_bf16 v[44:47], v[132:135], v[212:215], v[44:47]
    ds_read_b64_tr_b16 v[210:211], v244 offset:12288
    s_waitcnt lgkmcnt(6)
    v_mfma_f32_16x16x32_bf16 v[32:35], v[136:139], v[192:195], v[32:35]
    ds_read_b64_tr_b16 v[212:213], v245 offset:8192
    v_mfma_f32_16x16x32_bf16 v[40:43], v[140:143], v[192:195], v[40:43]
    ds_read_b64_tr_b16 v[214:215], v245 offset:12288
    v_mfma_f32_16x16x32_bf16 v[36:39], v[136:139], v[196:199], v[36:39]
    ds_read_b64_tr_b16 v[192:193], v244 offset:16384
    v_mfma_f32_16x16x32_bf16 v[44:47], v[140:143], v[196:199], v[44:47]
    ds_read_b64_tr_b16 v[194:195], v244 offset:20480
    s_waitcnt lgkmcnt(6)
    v_mfma_f32_16x16x32_bf16 v[32:35], v[144:147], v[200:203], v[32:35]
    ds_read_b64_tr_b16 v[196:197], v245 offset:16384
    v_mfma_f32_16x16x32_bf16 v[40:43], v[148:151], v[200:203], v[40:43]
    ds_read_b64_tr_b16 v[198:199], v245 offset:20480
    v_mfma_f32_16x16x32_bf16 v[36:39], v[144:147], v[204:207], v[36:39]
    ds_read_b64_tr_b16 v[200:201], v244 offset:24576
    v_mfma_f32_16x16x32_bf16 v[44:47], v[148:151], v[204:207], v[44:47]
    ds_read_b64_tr_b16 v[202:203], v244 offset:28672
    s_waitcnt lgkmcnt(6)
    v_mfma_f32_16x16x32_bf16 v[32:35], v[152:155], v[208:211], v[32:35]
    ds_read_b64_tr_b16 v[204:205], v245 offset:24576
    v_mfma_f32_16x16x32_bf16 v[40:43], v[156:159], v[208:211], v[40:43]
    ds_read_b64_tr_b16 v[206:207], v245 offset:28672
    v_mfma_f32_16x16x32_bf16 v[36:39], v[152:155], v[212:215], v[36:39]
    ds_read_b64_tr_b16 v[208:209], v244 offset:32768
    v_mfma_f32_16x16x32_bf16 v[44:47], v[156:159], v[212:215], v[44:47]
    ds_read_b64_tr_b16 v[210:211], v244 offset:36864
    s_waitcnt lgkmcnt(6)
    v_mfma_f32_16x16x32_bf16 v[32:35], v[160:163], v[192:195], v[32:35]
    ds_read_b64_tr_b16 v[212:213], v245 offset:32768
    v_mfma_f32_16x16x32_bf16 v[40:43], v[164:167], v[192:195], v[40:43]
    ds_read_b64_tr_b16 v[214:215], v245 offset:36864
    v_mfma_f32_16x16x32_bf16 v[36:39], v[160:163], v[196:199], v[36:39]
    ds_read_b64_tr_b16 v[192:193], v244 offset:40960
    ds_read_b32 v14, v16 offset:32
    v_mfma_f32_16x16x32_bf16 v[44:47], v[164:167], v[196:199], v[44:47]
    ds_read_b64_tr_b16 v[194:195], v244 offset:45056
    s_waitcnt lgkmcnt(7)
    v_mfma_f32_16x16x32_bf16 v[32:35], v[168:171], v[200:203], v[32:35]
    ds_read_b64_tr_b16 v[196:197], v245 offset:40960
    v_mfma_f32_16x16x32_bf16 v[40:43], v[172:175], v[200:203], v[40:43]
    ds_read_b64_tr_b16 v[198:199], v245 offset:45056
    v_mfma_f32_16x16x32_bf16 v[36:39], v[168:171], v[204:207], v[36:39]
    v_mfma_f32_16x16x32_bf16 v[44:47], v[172:175], v[204:207], v[44:47]
    s_waitcnt lgkmcnt(5)
    v_mfma_f32_16x16x32_bf16 v[32:35], v[176:179], v[208:211], v[32:35]
    v_mfma_f32_16x16x32_bf16 v[40:43], v[180:183], v[208:211], v[40:43]
    v_mfma_f32_16x16x32_bf16 v[36:39], v[176:179], v[212:215], v[36:39]
    s_waitcnt lgkmcnt(3)
    v_cmp_gt_u32 vcc, 3, v14
    s_cbranch_vccz L_sd_go
L_sd:
    ds_read_b32 v14, v16 offset:32
    s_waitcnt lgkmcnt(0)
    v_cmp_gt_u32 vcc, 3, v14
    s_cbranch_vccnz L_sd
L_sd_go:
    v_mfma_f32_16x16x32_bf16 v[44:47], v[180:183], v[212:215], v[44:47]
    s_waitcnt lgkmcnt(0)
    v_mfma_f32_16x16x32_bf16 v[32:35], v[184:187], v[192:195], v[32:35]
    v_mfma_f32_16x16x32_bf16 v[40:43], v[188:191], v[192:195], v[40:43]
    v_mfma_f32_16x16x32_bf16 v[36:39], v[184:187], v[196:199], v[36:39]
    v_mfma_f32_16x16x32_bf16 v[44:47], v[188:191], v[196:199], v[44:47]
    s_nop 6
    ds_write_b128 v19, v[32:35] offset:0
    ds_write_b128 v19, v[36:39] offset:1024
    s_waitcnt vmcnt(0)
    buffer_store_dwordx2 v[28:29], v26, s[44:47], 0 offen sc1
    s_waitcnt lgkmcnt(0)
    s_barrier
L_pp:
    ds_read_b32 v17, v8 offset:0
    s_waitcnt lgkmcnt(0)
    v_cmp_gt_u32 vcc, 14, v17
    s_cbranch_vccnz L_pp
    buffer_load_dwordx4 v[128:131], v22, s[44:47], s74 offen offset:2048 sc1
    buffer_load_dwordx4 v[132:135], v22, s[44:47], s75 offen offset:2048 sc1
    buffer_load_dwordx4 v[136:139], v22, s[44:47], s76 offen offset:2048 sc1
    s_waitcnt vmcnt(2)
    v_lshlrev_b32 v140, 16, v128
    v_and_b32 v141, 0xffff0000, v128
    v_lshlrev_b32 v142, 16, v129
    v_and_b32 v143, 0xffff0000, v129
    v_lshlrev_b32 v144, 16, v130
    v_and_b32 v145, 0xffff0000, v130
    v_lshlrev_b32 v146, 16, v131
    v_and_b32 v147, 0xffff0000, v131
    v_pk_add_f32 v[40:41], v[40:41], v[140:141]
    v_pk_add_f32 v[42:43], v[42:43], v[142:143]
    v_pk_add_f32 v[44:45], v[44:45], v[144:145]
    v_pk_add_f32 v[46:47], v[46:47], v[146:147]
    s_waitcnt vmcnt(1)
    v_lshlrev_b32 v140, 16, v132
    v_and_b32 v141, 0xffff0000, v132
    v_lshlrev_b32 v142, 16, v133
    v_and_b32 v143, 0xffff0000, v133
    v_lshlrev_b32 v144, 16, v134
    v_and_b32 v145, 0xffff0000, v134
    v_lshlrev_b32 v146, 16, v135
    v_and_b32 v147, 0xffff0000, v135
    v_pk_add_f32 v[40:41], v[40:41], v[140:141]
    v_pk_add_f32 v[42:43], v[42:43], v[142:143]
    v_pk_add_f32 v[44:45], v[44:45], v[144:145]
    v_pk_add_f32 v[46:47], v[46:47], v[146:147]
    s_waitcnt vmcnt(0)
    v_lshlrev_b32 v140, 16, v136
    v_and_b32 v141, 0xffff0000, v136
    v_lshlrev_b32 v142, 16, v137
    v_and_b32 v143, 0xffff0000, v137
    v_lshlrev_b32 v144, 16, v138
    v_and_b32 v145, 0xffff0000, v138
    v_lshlrev_b32 v146, 16, v139
    v_and_b32 v147, 0xffff0000, v139
    v_pk_add_f32 v[40:41], v[40:41], v[140:141]
    v_pk_add_f32 v[42:43], v[42:43], v[142:143]
    v_pk_add_f32 v[44:45], v[44:45], v[144:145]
    v_pk_add_f32 v[46:47], v[46:47], v[146:147]
    s_nop 0
    v_permlane16_swap_b32 v40, v44
    buffer_store_dword v40, v21, s[68:71], 0 offen offset:0 nt
    buffer_store_dword v44, v21, s[68:71], s24 offen offset:0 nt
    v_permlane16_swap_b32 v41, v45
    buffer_store_dword v41, v21, s[68:71], 0 offen offset:2048 nt
    buffer_store_dword v45, v21, s[68:71], s24 offen offset:2048 nt
    v_permlane16_swap_b32 v42, v46
    buffer_store_dword v42, v21, s[68:71], s74 offen offset:0 nt
    buffer_store_dword v46, v21, s[68:71], s25 offen offset:0 nt
    v_permlane16_swap_b32 v43, v47
    buffer_store_dword v43, v21, s[68:71], s74 offen offset:2048 nt
    buffer_store_dword v47, v21, s[68:71], s25 offen offset:2048 nt
L_p2_done:
L_end:
    s_endpgm
    .p2align 6
L_tab:
    .long 0, 1, 2, 3, 4, 5, 6, 7, 8, 9, 10, 11, 12, 13, 14, 15
L_codeend:
.section .rodata,"a"
.p2align 6
.amdhsa_kernel gated_mix__ssm_conv_s5__swiglu_ffn__prompt_kernel
  .amdhsa_next_free_vgpr 256
  .amdhsa_next_free_sgpr 102
  .amdhsa_accum_offset 256
  .amdhsa_group_segment_fixed_size 0
  .amdhsa_kernarg_size 136
  .amdhsa_user_sgpr_count 2
  .amdhsa_user_sgpr_kernarg_segment_ptr 1
  .amdhsa_system_sgpr_workgroup_id_x 1
.end_amdhsa_kernel
```
